```python
import torch

def _softmax(x, axis=-1):
    return torch.softmax(x, dim=axis)
def _gelu(x):
    return torch.nn.functional.gelu(x, approximate="tanh")
def _silu(x):
    return torch.nn.functional.silu(x)
def _sigmoid(x):
    return torch.sigmoid(x)
def _layernorm(x, axis=-1, eps=1e-5):
    m = x.mean(dim=axis, keepdim=True)
    v = x.var(dim=axis, keepdim=True, unbiased=False)
    return (x - m) / torch.sqrt(v + eps)
def _scatter_add(tgt, idx, src, axis=0):
    return tgt.clone().index_add_(axis, idx, src)
def _segment_sum(src, seg, n):
    out = torch.zeros((n,) + src.shape[1:], dtype=src.dtype)
    return out.index_add_(0, seg, src)
def _pad(x, pw):
    flat = tuple(v for pair in reversed(pw) for v in pair)
    return torch.nn.functional.pad(x, flat)

kernel_name = 'parallel_sum__softmax_full_mha__mixer_channel_mlp__prompt'

def setup_inputs():

    _w = (lambda a: (lambda t: t.to(torch.bfloat16) if t.is_floating_point() else t)(torch.as_tensor(a)))
    def _A_setup():
        B, S, D = 1, 2048, 512
        return {
            "x": _w((lambda *s: torch.randn(*s, dtype=torch.bfloat16) * 0.05)(B, S, D)),
            "wqkv": _w((lambda *s: torch.randn(*s, dtype=torch.bfloat16) * 0.05)(D, 3 * D)),
            "wo": _w((lambda *s: torch.randn(*s, dtype=torch.bfloat16) * 0.05)(D, D)),
        }
    _A_in = _A_setup()

    def _B_setup():
        B, S, D, F = 1, 2048, 512, 1376
        return {
            "x": _w((lambda *s: torch.randn(*s, dtype=torch.bfloat16) * 0.05)(B, S, D)),
            "w1": _w((lambda *s: torch.randn(*s, dtype=torch.bfloat16) * 3.2)(D, F) * (D ** -0.5)),
            "b1": _w((lambda *s: torch.randn(*s, dtype=torch.bfloat16) * 1.6)(F)),
            "w2": _w((lambda *s: torch.randn(*s, dtype=torch.bfloat16) * 0.05)(F, D) * (F ** -0.5)),
            "b2": _w((lambda *s: torch.randn(*s, dtype=torch.bfloat16) * 0.1)(D)),
        }
    _B_in = _B_setup()

    return {
        "A_x": _A_in["x"],
        "A_wqkv": _A_in["wqkv"],
        "A_wo": _A_in["wo"],
        "B_x": _B_in["x"],
        "B_w1": _B_in["w1"],
        "B_b1": _B_in["b1"],
        "B_w2": _B_in["w2"],
        "B_b2": _B_in["b2"],
    }

def reference(A_x, A_wqkv, A_wo, B_x, B_w1, B_b1, B_w2, B_b2):
    def _A_ref(x, wqkv, wo):
        B, S, D = x.shape
        H = 32; Dh = D // H
        qkv = (lambda x, *d: x.permute(*d))((x @ wqkv).reshape(B, S, 3, H, Dh), 2, 0, 3, 1, 4)
        q, k, v = qkv[0], qkv[1], qkv[2]
        scale = Dh ** -0.5
        scores = torch.einsum("bhqd,bhkd->bhqk", q, k) * scale
        p = _softmax(scores, axis=-1)
        o = torch.einsum("bhqk,bhkd->bhqd", p, v)
        return (lambda x, *d: x.permute(*d))(o, 0, 2, 1, 3).reshape(B, S, D) @ wo

    def _B_ref(x, w1, b1, w2, b2):
        y = _layernorm(x, axis=-1)
        h = _gelu(torch.einsum("bsd,df->bsf", y, w1) + b1)
        return torch.einsum("bsf,fd->bsd", h, w2) + b2

    x = A_x
    xn = _layernorm(x, axis=-1)
    return x + _A_ref(xn, A_wqkv, A_wo) + _B_ref(xn, B_w1, B_b1, B_w2, B_b2)
```

```asm
; @launch grid=(256,1,1) block=(512,1,1) lds=163840
.amdgcn_target "amdgcn-amd-amdhsa--gfx950"
.text
.globl parallel_sum__softmax_full_mha__mixer_channel_mlp__prompt_kernel
.p2align 8
.type parallel_sum__softmax_full_mha__mixer_channel_mlp__prompt_kernel,@function
parallel_sum__softmax_full_mha__mixer_channel_mlp__prompt_kernel:
  s_cmp_ge_u32 s2, 256
  s_cbranch_scc1 L_end
  s_load_dwordx16 s[4:19], s[0:1], 0
  s_load_dwordx4 s[20:23], s[0:1], 64
  s_load_dwordx2 s[24:25], s[0:1], 80
  v_lshrrev_b32 v2, 6, v0
  v_and_b32 v1, 63, v0
  s_nop 0
  v_readfirstlane_b32 s26, v2
  s_cmp_eq_u32 s26, 7
  s_cbranch_scc0 L_ipf
  s_getpc_b64 s[62:63]
  s_and_b32 s62, s62, 0xffffff00
  s_lshr_b32 s61, s2, 3
  s_lshl_b32 s61, s61, 11
  v_and_b32 v3, 15, v1
  v_lshlrev_b32 v3, 7, v3
  v_add_u32 v3, s61, v3
  v_min_u32 v3, L_end-parallel_sum__softmax_full_mha__mixer_channel_mlp__prompt_kernel-4, v3
  global_load_dword v255, v3, s[62:63]
L_ipf:
  s_and_b32 s46, s2, 7
  s_lshr_b32 s47, s2, 3
  s_and_b32 s44, s46, 1
  s_lshl_b32 s44, s44, 3
  s_and_b32 s48, s47, 7
  s_add_u32 s44, s44, s48
  s_lshr_b32 s45, s46, 1
  s_lshl_b32 s45, s45, 2
  s_lshr_b32 s48, s47, 3
  s_add_u32 s45, s45, s48
  s_and_b32 s69, s47, 7
  s_lshr_b32 s48, s47, 3
  s_lshl_b32 s48, s48, 1
  s_add_u32 s69, s69, s48
  s_and_b32 s69, s69, 7
  s_mov_b32 s69, 0
  s_mul_i32 s53, s45, 6
  s_mul_i32 s46, s45, 5
  s_add_u32 s46, s46, 6
  s_cmp_lt_u32 s45, 6
  s_cselect_b32 s53, s53, s46
  s_cmp_lt_u32 s45, 6
  s_cselect_b32 s70, 6, 5
  v_lshrrev_b32 v6, 3, v1
  v_lshlrev_b32 v6, 10, v6
  v_and_b32 v7, 7, v1
  v_lshrrev_b32 v12, 4, v1
  v_add_u32 v13, 0, v12
  v_xor_b32 v13, v13, v7
  v_lshl_add_u32 v2, v13, 4, v6
  v_add_u32 v13, 4, v12
  v_xor_b32 v13, v13, v7
  v_lshl_add_u32 v3, v13, 4, v6
  v_add_u32 v6, 0, v1
  v_mul_u32_u24 v7, 171, v6
  v_lshrrev_b32 v7, 11, v7
  v_mul_u32_u24 v12, 12, v7
  v_sub_u32 v12, v6, v12
  v_lshlrev_b32 v12, 4, v12
  s_nop 0
  v_mul_u32_u24 v13, 3072, v7
  v_add_u32 v16, v13, v12
  v_mul_u32_u24 v13, 2752, v7
  v_add_u32 v20, v13, v12
  v_add_u32 v6, 64, v1
  v_mul_u32_u24 v7, 171, v6
  v_lshrrev_b32 v7, 11, v7
  v_mul_u32_u24 v12, 12, v7
  v_sub_u32 v12, v6, v12
  v_lshlrev_b32 v12, 4, v12
  v_subrev_u32 v12, 1024, v12
  v_mul_u32_u24 v13, 3072, v7
  v_add_u32 v17, v13, v12
  v_mul_u32_u24 v13, 2752, v7
  v_add_u32 v21, v13, v12
  v_add_u32 v6, 128, v1
  v_mul_u32_u24 v7, 171, v6
  v_lshrrev_b32 v7, 11, v7
  v_mul_u32_u24 v12, 12, v7
  v_sub_u32 v12, v6, v12
  v_lshlrev_b32 v12, 4, v12
  v_subrev_u32 v12, 2048, v12
  v_mul_u32_u24 v13, 3072, v7
  v_add_u32 v18, v13, v12
  v_mul_u32_u24 v13, 2752, v7
  v_add_u32 v22, v13, v12
  s_waitcnt lgkmcnt(0)
  s_mov_b32 s28, s4
  s_and_b32 s29, s5, 0xffff
  s_mov_b32 s30, 0x200000
  s_mov_b32 s31, 0x20000
  s_mov_b32 s32, s24
  s_and_b32 s33, s25, 0xffff
  s_mov_b32 s34, 0x1200000
  s_mov_b32 s35, 0x20000
  s_cmp_ge_u32 s26, 4
  s_cbranch_scc1 L_producer
  v_lshlrev_b32 v6, 4, v1
  s_lshl_b32 s68, s2, 3
  s_lshl_b32 s46, s26, 1
  s_add_u32 s68, s68, s46
  s_lshl_b32 s46, s68, 10
  buffer_load_dwordx4 v[8:11], v6, s[28:31], s46 offen
  buffer_load_dwordx4 v[12:15], v6, s[28:31], s46 offen offset:1024
  s_setprio 1
  s_and_b32 s54, s26, 1
  s_lshr_b32 s55, s26, 1
  s_or_b32 s46, s2, s26
  s_cmp_eq_u32 s46, 0
  s_cbranch_scc0 L_noepoch
  s_memrealtime s[46:47]
  s_mov_b32 s36, s22
  s_and_b32 s37, s23, 0xffff
  s_mov_b32 s38, 0x100
  s_mov_b32 s39, 0x20000
  s_waitcnt lgkmcnt(0)
  s_or_b32 s46, s46, 1
  v_mov_b32 v6, s46
  v_mov_b32 v7, 0
  s_mov_b64 exec, 1
  buffer_store_dword v6, v7, s[36:39], 0 offen sc1
  s_mov_b64 exec, -1
L_noepoch:
  v_and_b32 v18, 31, v1
  v_lshrrev_b32 v19, 5, v1
  v_bfe_u32 v20, v18, 1, 3
  s_lshl_b32 s46, s26, 5
  v_add_u32 v21, s46, v18
  v_lshlrev_b32 v21, 7, v21
  v_add_u32 v22, 0, v19
  v_xor_b32 v22, v22, v20
  v_lshl_add_u32 v2, v22, 4, v21
  v_add_u32 v22, 2, v19
  v_xor_b32 v22, v22, v20
  v_lshl_add_u32 v3, v22, 4, v21
  v_add_u32 v22, 4, v19
  v_xor_b32 v22, v22, v20
  v_lshl_add_u32 v4, v22, 4, v21
  v_add_u32 v22, 6, v19
  v_xor_b32 v22, v22, v20
  v_lshl_add_u32 v5, v22, 4, v21
  v_bfe_u32 v20, v1, 2, 2
  v_lshl_add_u32 v21, v19, 3, v20
  v_mul_u32_u24 v21, 192, v21
  v_bfe_u32 v22, v1, 4, 1
  v_lshl_add_u32 v21, v22, 5, v21
  v_and_b32 v22, 3, v1
  v_lshl_add_u32 v21, v22, 3, v21
  v_add_u32 v48, 98304, v21
  s_waitcnt vmcnt(0)
  v_lshlrev_b32 v16, 16, v8
  v_and_b32 v17, 0xffff0000, v8
  v_lshlrev_b32 v18, 16, v9
  v_and_b32 v19, 0xffff0000, v9
  v_lshlrev_b32 v20, 16, v10
  v_and_b32 v21, 0xffff0000, v10
  v_lshlrev_b32 v22, 16, v11
  v_and_b32 v23, 0xffff0000, v11
  v_lshlrev_b32 v24, 16, v12
  v_and_b32 v25, 0xffff0000, v12
  v_lshlrev_b32 v26, 16, v13
  v_and_b32 v27, 0xffff0000, v13
  v_lshlrev_b32 v28, 16, v14
  v_and_b32 v29, 0xffff0000, v14
  v_lshlrev_b32 v30, 16, v15
  v_and_b32 v31, 0xffff0000, v15
  v_add_f32 v32, v16, v17
  v_mul_f32 v33, v16, v16
  v_fmac_f32 v33, v17, v17
  v_add_f32 v32, v32, v18
  v_fmac_f32 v33, v18, v18
  v_add_f32 v32, v32, v19
  v_fmac_f32 v33, v19, v19
  v_add_f32 v32, v32, v20
  v_fmac_f32 v33, v20, v20
  v_add_f32 v32, v32, v21
  v_fmac_f32 v33, v21, v21
  v_add_f32 v32, v32, v22
  v_fmac_f32 v33, v22, v22
  v_add_f32 v32, v32, v23
  v_fmac_f32 v33, v23, v23
  v_add_f32 v34, v24, v25
  v_mul_f32 v35, v24, v24
  v_fmac_f32 v35, v25, v25
  v_add_f32 v34, v34, v26
  v_fmac_f32 v35, v26, v26
  v_add_f32 v34, v34, v27
  v_fmac_f32 v35, v27, v27
  v_add_f32 v34, v34, v28
  v_fmac_f32 v35, v28, v28
  v_add_f32 v34, v34, v29
  v_fmac_f32 v35, v29, v29
  v_add_f32 v34, v34, v30
  v_fmac_f32 v35, v30, v30
  v_add_f32 v34, v34, v31
  v_fmac_f32 v35, v31, v31
  s_nop 1
  v_add_f32_dpp v32, v32, v32 row_shr:1 row_mask:0xf bank_mask:0xf
  v_add_f32_dpp v33, v33, v33 row_shr:1 row_mask:0xf bank_mask:0xf
  v_add_f32_dpp v34, v34, v34 row_shr:1 row_mask:0xf bank_mask:0xf
  v_add_f32_dpp v35, v35, v35 row_shr:1 row_mask:0xf bank_mask:0xf
  v_add_f32_dpp v32, v32, v32 row_shr:2 row_mask:0xf bank_mask:0xf
  v_add_f32_dpp v33, v33, v33 row_shr:2 row_mask:0xf bank_mask:0xf
  v_add_f32_dpp v34, v34, v34 row_shr:2 row_mask:0xf bank_mask:0xf
  v_add_f32_dpp v35, v35, v35 row_shr:2 row_mask:0xf bank_mask:0xf
  v_add_f32_dpp v32, v32, v32 row_shr:4 row_mask:0xf bank_mask:0xf
  v_add_f32_dpp v33, v33, v33 row_shr:4 row_mask:0xf bank_mask:0xf
  v_add_f32_dpp v34, v34, v34 row_shr:4 row_mask:0xf bank_mask:0xf
  v_add_f32_dpp v35, v35, v35 row_shr:4 row_mask:0xf bank_mask:0xf
  v_add_f32_dpp v32, v32, v32 row_shr:8 row_mask:0xf bank_mask:0xf
  v_add_f32_dpp v33, v33, v33 row_shr:8 row_mask:0xf bank_mask:0xf
  v_add_f32_dpp v34, v34, v34 row_shr:8 row_mask:0xf bank_mask:0xf
  v_add_f32_dpp v35, v35, v35 row_shr:8 row_mask:0xf bank_mask:0xf
  v_add_f32_dpp v32, v32, v32 row_bcast:15 row_mask:0xa bank_mask:0xf
  v_add_f32_dpp v33, v33, v33 row_bcast:15 row_mask:0xa bank_mask:0xf
  v_add_f32_dpp v34, v34, v34 row_bcast:15 row_mask:0xa bank_mask:0xf
  v_add_f32_dpp v35, v35, v35 row_bcast:15 row_mask:0xa bank_mask:0xf
  v_add_f32_dpp v32, v32, v32 row_bcast:31 row_mask:0xc bank_mask:0xf
  v_add_f32_dpp v33, v33, v33 row_bcast:31 row_mask:0xc bank_mask:0xf
  v_add_f32_dpp v34, v34, v34 row_bcast:31 row_mask:0xc bank_mask:0xf
  v_add_f32_dpp v35, v35, v35 row_bcast:31 row_mask:0xc bank_mask:0xf
  s_nop 0
  v_readlane_b32 s60, v32, 63
  v_readlane_b32 s61, v33, 63
  v_readlane_b32 s62, v34, 63
  v_readlane_b32 s63, v35, 63
  s_nop 1
  v_mov_b32 v36, s60
  v_mov_b32 v37, s61
  v_mov_b32 v38, s62
  v_mov_b32 v39, s63
  s_mov_b32 s62, 0
  s_mov_b32 s63, -1
  v_cndmask_b32 v36, v36, v38, s[62:63]
  v_cndmask_b32 v37, v37, v39, s[62:63]
  v_mul_f32 v36, 0x3b000000, v36
  v_mul_f32 v37, 0x3b000000, v37
  v_fma_f32 v37, -v36, v36, v37
  v_max_f32 v37, 0, v37
  v_cvt_pk_bf16_f32 v38, v36, v36
  v_and_b32 v38, 0xffff0000, v38
  v_cvt_pk_bf16_f32 v39, v37, v37
  v_and_b32 v39, 0xffff0000, v39
  v_add_f32 v39, 0x3727c5ac, v39
  v_cvt_pk_bf16_f32 v39, v39, v39
  v_and_b32 v39, 0xffff0000, v39
  v_sqrt_f32 v39, v39
  s_nop 0
  v_cvt_pk_bf16_f32 v39, v39, v39
  v_and_b32 v39, 0xffff0000, v39
  v_rcp_f32 v40, v39
  s_nop 0
  v_fma_f32 v41, -v39, v40, 1.0
  v_fma_f32 v40, v40, v41, v40
  v_sub_f32 v32, v36, v38
  v_mul_f32 v32, v32, v40
  v_mul_f32 v33, v37, v40
  v_mul_f32 v33, v33, v40
  v_cvt_pk_bf16_f32 v34, v32, v32
  v_and_b32 v34, 0xffff0000, v34
  v_cvt_pk_bf16_f32 v35, v33, v33
  v_and_b32 v35, 0xffff0000, v35
  v_add_f32 v35, 0x3727c5ac, v35
  v_cvt_pk_bf16_f32 v35, v35, v35
  v_and_b32 v35, 0xffff0000, v35
  v_sqrt_f32 v35, v35
  s_nop 0
  v_cvt_pk_bf16_f32 v35, v35, v35
  v_and_b32 v35, 0xffff0000, v35
  v_rcp_f32 v42, v35
  s_nop 0
  v_fma_f32 v41, -v35, v42, 1.0
  v_fma_f32 v42, v42, v41, v42
  v_mov_b32 v44, v40
  v_mul_f32 v45, v38, v40
  v_mul_f32 v46, v40, v42
  v_mul_f32 v47, v34, v42
  v_fmac_f32 v47, v38, v46
  s_lshl_b32 s46, s68, 4
  s_add_u32 s46, s46, 0
  v_lshrrev_b32 v7, 5, v1
  v_lshlrev_b32 v7, 4, v7
  s_mov_b32 exec_lo, 1
  s_mov_b32 exec_hi, 1
  buffer_store_dwordx4 v[44:47], v7, s[32:35], s46 offen sc1
  s_mov_b64 exec, -1
  s_nop 1
  v_mov_b32 v6, v48
  v_and_b32 v14, 31, v1
  v_lshrrev_b32 v15, 5, v1
  s_lshl_b32 s59, s44, 2
  s_add_u32 s59, s59, s26
  v_lshlrev_b32 v8, 4, v1
  v_lshlrev_b32 v9, 5, v14
  v_lshl_add_u32 v9, v15, 4, v9
  s_mul_i32 s46, s45, 6
  s_add_u32 s46, s46, 0
  s_lshr_b32 s47, s46, 5
  s_and_b32 s46, s46, 31
  s_cmp_eq_u32 s47, 2
  s_cselect_b64 s[50:51], -1, 0
  v_cndmask_b32 v20, v8, v9, s[50:51]
  s_cmp_eq_u32 s47, 0
  s_cselect_b32 s36, 0x3eb8aa3b, 1.0
  s_lshl_b32 s61, s47, 21
  s_add_u32 s61, s61, 2097152
  s_lshl_b32 s46, s46, 6
  s_add_u32 s46, s46, s59
  s_lshl_b32 s46, s46, 10
  s_add_u32 s40, s61, s46
  s_mul_i32 s46, s45, 6
  s_add_u32 s46, s46, 2
  s_lshr_b32 s47, s46, 5
  s_and_b32 s46, s46, 31
  s_cmp_eq_u32 s47, 2
  s_cselect_b64 s[50:51], -1, 0
  v_cndmask_b32 v21, v8, v9, s[50:51]
  s_cmp_eq_u32 s47, 0
  s_cselect_b32 s37, 0x3eb8aa3b, 1.0
  s_lshl_b32 s61, s47, 21
  s_add_u32 s61, s61, 2097152
  s_lshl_b32 s46, s46, 6
  s_add_u32 s46, s46, s59
  s_lshl_b32 s46, s46, 10
  s_add_u32 s41, s61, s46
  s_mul_i32 s46, s45, 6
  s_add_u32 s46, s46, 4
  s_lshr_b32 s47, s46, 5
  s_and_b32 s46, s46, 31
  s_cmp_eq_u32 s47, 2
  s_cselect_b64 s[50:51], -1, 0
  v_cndmask_b32 v22, v8, v9, s[50:51]
  s_cmp_eq_u32 s47, 0
  s_cselect_b32 s38, 0x3eb8aa3b, 1.0
  s_lshl_b32 s61, s47, 21
  s_add_u32 s61, s61, 2097152
  s_lshl_b32 s46, s46, 6
  s_add_u32 s46, s46, s59
  s_lshl_b32 s46, s46, 10
  s_add_u32 s42, s61, s46
  s_waitcnt lgkmcnt(0)
  s_barrier
  v_add_u32 v180, 65536, v2
  v_add_u32 v181, 65536, v3
  v_add_u32 v182, 65536, v4
  v_add_u32 v183, 65536, v5
  ds_read_b128 v[128:131], v2 offset:0
  ds_read_b64_tr_b16 v[140:141], v6 offset:0
  ds_read_b64_tr_b16 v[142:143], v6 offset:768
  ds_read_b64_tr_b16 v[144:145], v6 offset:64
  ds_read_b64_tr_b16 v[146:147], v6 offset:832
  ds_read_b64_tr_b16 v[148:149], v6 offset:128
  ds_read_b64_tr_b16 v[150:151], v6 offset:896
  ds_read_b128 v[132:135], v3 offset:0
  ds_read_b64_tr_b16 v[152:153], v6 offset:3072
  ds_read_b64_tr_b16 v[154:155], v6 offset:3840
  ds_read_b64_tr_b16 v[156:157], v6 offset:3136
  ds_read_b64_tr_b16 v[158:159], v6 offset:3904
  ds_read_b64_tr_b16 v[160:161], v6 offset:3200
  ds_read_b64_tr_b16 v[162:163], v6 offset:3968
  s_waitcnt lgkmcnt(0)
  v_mfma_f32_32x32x16_bf16 v[32:47], v[140:143], v[128:131], 0
  s_barrier
  ds_read_b128 v[136:139], v4 offset:0
  ds_read_b64_tr_b16 v[164:165], v6 offset:6144
  ds_read_b64_tr_b16 v[166:167], v6 offset:6912
  v_mfma_f32_32x32x16_bf16 v[48:63], v[144:147], v[128:131], 0
  ds_read_b64_tr_b16 v[168:169], v6 offset:6208
  ds_read_b64_tr_b16 v[170:171], v6 offset:6976
  ds_read_b64_tr_b16 v[172:173], v6 offset:6272
  ds_read_b64_tr_b16 v[174:175], v6 offset:7040
  v_mfma_f32_32x32x16_bf16 v[64:79], v[148:151], v[128:131], 0
  s_waitcnt lgkmcnt(7)
  v_mfma_f32_32x32x16_bf16 v[32:47], v[152:155], v[132:135], v[32:47]
  ds_read_b128 v[128:131], v5 offset:0
  ds_read_b64_tr_b16 v[140:141], v6 offset:9216
  ds_read_b64_tr_b16 v[142:143], v6 offset:9984
  v_mfma_f32_32x32x16_bf16 v[48:63], v[156:159], v[132:135], v[48:63]
  ds_read_b64_tr_b16 v[144:145], v6 offset:9280
  ds_read_b64_tr_b16 v[146:147], v6 offset:10048
  ds_read_b64_tr_b16 v[148:149], v6 offset:9344
  ds_read_b64_tr_b16 v[150:151], v6 offset:10112
  v_mfma_f32_32x32x16_bf16 v[64:79], v[160:163], v[132:135], v[64:79]
  s_waitcnt lgkmcnt(7)
  v_mfma_f32_32x32x16_bf16 v[32:47], v[164:167], v[136:139], v[32:47]
  s_barrier
  ds_read_b128 v[132:135], v2 offset:16384
  ds_read_b64_tr_b16 v[152:153], v6 offset:12288
  ds_read_b64_tr_b16 v[154:155], v6 offset:13056
  v_mfma_f32_32x32x16_bf16 v[48:63], v[168:171], v[136:139], v[48:63]
  ds_read_b64_tr_b16 v[156:157], v6 offset:12352
  ds_read_b64_tr_b16 v[158:159], v6 offset:13120
  ds_read_b64_tr_b16 v[160:161], v6 offset:12416
  ds_read_b64_tr_b16 v[162:163], v6 offset:13184
  v_mfma_f32_32x32x16_bf16 v[64:79], v[172:175], v[136:139], v[64:79]
  s_waitcnt lgkmcnt(7)
  v_mfma_f32_32x32x16_bf16 v[32:47], v[140:143], v[128:131], v[32:47]
  ds_read_b128 v[136:139], v3 offset:16384
  ds_read_b64_tr_b16 v[164:165], v6 offset:15360
  ds_read_b64_tr_b16 v[166:167], v6 offset:16128
  v_mfma_f32_32x32x16_bf16 v[48:63], v[144:147], v[128:131], v[48:63]
  ds_read_b64_tr_b16 v[168:169], v6 offset:15424
  ds_read_b64_tr_b16 v[170:171], v6 offset:16192
  ds_read_b64_tr_b16 v[172:173], v6 offset:15488
  ds_read_b64_tr_b16 v[174:175], v6 offset:16256
  v_mfma_f32_32x32x16_bf16 v[64:79], v[148:151], v[128:131], v[64:79]
  s_waitcnt lgkmcnt(7)
  v_mfma_f32_32x32x16_bf16 v[32:47], v[152:155], v[132:135], v[32:47]
  s_barrier
  ds_read_b128 v[128:131], v4 offset:16384
  ds_read_b64_tr_b16 v[140:141], v6 offset:18432
  ds_read_b64_tr_b16 v[142:143], v6 offset:19200
  v_mfma_f32_32x32x16_bf16 v[48:63], v[156:159], v[132:135], v[48:63]
  ds_read_b64_tr_b16 v[144:145], v6 offset:18496
  ds_read_b64_tr_b16 v[146:147], v6 offset:19264
  ds_read_b64_tr_b16 v[148:149], v6 offset:18560
  ds_read_b64_tr_b16 v[150:151], v6 offset:19328
  v_mfma_f32_32x32x16_bf16 v[64:79], v[160:163], v[132:135], v[64:79]
  s_waitcnt lgkmcnt(7)
  v_mfma_f32_32x32x16_bf16 v[32:47], v[164:167], v[136:139], v[32:47]
  ds_read_b128 v[132:135], v5 offset:16384
  ds_read_b64_tr_b16 v[152:153], v6 offset:21504
  ds_read_b64_tr_b16 v[154:155], v6 offset:22272
  v_mfma_f32_32x32x16_bf16 v[48:63], v[168:171], v[136:139], v[48:63]
  ds_read_b64_tr_b16 v[156:157], v6 offset:21568
  ds_read_b64_tr_b16 v[158:159], v6 offset:22336
  ds_read_b64_tr_b16 v[160:161], v6 offset:21632
  ds_read_b64_tr_b16 v[162:163], v6 offset:22400
  v_mfma_f32_32x32x16_bf16 v[64:79], v[172:175], v[136:139], v[64:79]
  s_waitcnt lgkmcnt(7)
  v_mfma_f32_32x32x16_bf16 v[32:47], v[140:143], v[128:131], v[32:47]
  s_barrier
  ds_read_b128 v[136:139], v2 offset:32768
  ds_read_b64_tr_b16 v[164:165], v6 offset:24576
  ds_read_b64_tr_b16 v[166:167], v6 offset:25344
  v_mfma_f32_32x32x16_bf16 v[48:63], v[144:147], v[128:131], v[48:63]
  ds_read_b64_tr_b16 v[168:169], v6 offset:24640
  ds_read_b64_tr_b16 v[170:171], v6 offset:25408
  ds_read_b64_tr_b16 v[172:173], v6 offset:24704
  ds_read_b64_tr_b16 v[174:175], v6 offset:25472
  v_mfma_f32_32x32x16_bf16 v[64:79], v[148:151], v[128:131], v[64:79]
  s_waitcnt lgkmcnt(7)
  v_mfma_f32_32x32x16_bf16 v[32:47], v[152:155], v[132:135], v[32:47]
  ds_read_b128 v[128:131], v3 offset:32768
  ds_read_b64_tr_b16 v[140:141], v6 offset:27648
  ds_read_b64_tr_b16 v[142:143], v6 offset:28416
  v_mfma_f32_32x32x16_bf16 v[48:63], v[156:159], v[132:135], v[48:63]
  ds_read_b64_tr_b16 v[144:145], v6 offset:27712
  ds_read_b64_tr_b16 v[146:147], v6 offset:28480
  ds_read_b64_tr_b16 v[148:149], v6 offset:27776
  ds_read_b64_tr_b16 v[150:151], v6 offset:28544
  v_mfma_f32_32x32x16_bf16 v[64:79], v[160:163], v[132:135], v[64:79]
  s_waitcnt lgkmcnt(7)
  v_mfma_f32_32x32x16_bf16 v[32:47], v[164:167], v[136:139], v[32:47]
  s_barrier
  ds_read_b128 v[132:135], v4 offset:32768
  ds_read_b64_tr_b16 v[152:153], v6 offset:30720
  ds_read_b64_tr_b16 v[154:155], v6 offset:31488
  v_mfma_f32_32x32x16_bf16 v[48:63], v[168:171], v[136:139], v[48:63]
  ds_read_b64_tr_b16 v[156:157], v6 offset:30784
  ds_read_b64_tr_b16 v[158:159], v6 offset:31552
  ds_read_b64_tr_b16 v[160:161], v6 offset:30848
  ds_read_b64_tr_b16 v[162:163], v6 offset:31616
  v_mfma_f32_32x32x16_bf16 v[64:79], v[172:175], v[136:139], v[64:79]
  s_waitcnt lgkmcnt(7)
  v_mfma_f32_32x32x16_bf16 v[32:47], v[140:143], v[128:131], v[32:47]
  ds_read_b128 v[136:139], v5 offset:32768
  ds_read_b64_tr_b16 v[164:165], v6 offset:33792
  ds_read_b64_tr_b16 v[166:167], v6 offset:34560
  v_mfma_f32_32x32x16_bf16 v[48:63], v[144:147], v[128:131], v[48:63]
  ds_read_b64_tr_b16 v[168:169], v6 offset:33856
  ds_read_b64_tr_b16 v[170:171], v6 offset:34624
  ds_read_b64_tr_b16 v[172:173], v6 offset:33920
  ds_read_b64_tr_b16 v[174:175], v6 offset:34688
  v_mfma_f32_32x32x16_bf16 v[64:79], v[148:151], v[128:131], v[64:79]
  s_waitcnt lgkmcnt(7)
  v_mfma_f32_32x32x16_bf16 v[32:47], v[152:155], v[132:135], v[32:47]
  s_waitcnt vmcnt(0)
  s_barrier
  ds_read_b128 v[128:131], v2 offset:49152
  ds_read_b64_tr_b16 v[140:141], v6 offset:0
  ds_read_b64_tr_b16 v[142:143], v6 offset:768
  v_mfma_f32_32x32x16_bf16 v[48:63], v[156:159], v[132:135], v[48:63]
  ds_read_b64_tr_b16 v[144:145], v6 offset:64
  ds_read_b64_tr_b16 v[146:147], v6 offset:832
  ds_read_b64_tr_b16 v[148:149], v6 offset:128
  ds_read_b64_tr_b16 v[150:151], v6 offset:896
  v_mfma_f32_32x32x16_bf16 v[64:79], v[160:163], v[132:135], v[64:79]
  s_waitcnt lgkmcnt(7)
  v_mfma_f32_32x32x16_bf16 v[32:47], v[164:167], v[136:139], v[32:47]
  ds_read_b128 v[132:135], v3 offset:49152
  ds_read_b64_tr_b16 v[152:153], v6 offset:3072
  ds_read_b64_tr_b16 v[154:155], v6 offset:3840
  v_mfma_f32_32x32x16_bf16 v[48:63], v[168:171], v[136:139], v[48:63]
  ds_read_b64_tr_b16 v[156:157], v6 offset:3136
  ds_read_b64_tr_b16 v[158:159], v6 offset:3904
  ds_read_b64_tr_b16 v[160:161], v6 offset:3200
  ds_read_b64_tr_b16 v[162:163], v6 offset:3968
  v_mfma_f32_32x32x16_bf16 v[64:79], v[172:175], v[136:139], v[64:79]
  s_waitcnt lgkmcnt(7)
  v_mfma_f32_32x32x16_bf16 v[32:47], v[140:143], v[128:131], v[32:47]
  s_barrier
  ds_read_b128 v[136:139], v4 offset:49152
  ds_read_b64_tr_b16 v[164:165], v6 offset:6144
  ds_read_b64_tr_b16 v[166:167], v6 offset:6912
  v_mfma_f32_32x32x16_bf16 v[48:63], v[144:147], v[128:131], v[48:63]
  ds_read_b64_tr_b16 v[168:169], v6 offset:6208
  ds_read_b64_tr_b16 v[170:171], v6 offset:6976
  ds_read_b64_tr_b16 v[172:173], v6 offset:6272
  ds_read_b64_tr_b16 v[174:175], v6 offset:7040
  v_mfma_f32_32x32x16_bf16 v[64:79], v[148:151], v[128:131], v[64:79]
  s_waitcnt lgkmcnt(7)
  v_mfma_f32_32x32x16_bf16 v[32:47], v[152:155], v[132:135], v[32:47]
  ds_read_b128 v[128:131], v5 offset:49152
  ds_read_b64_tr_b16 v[140:141], v6 offset:9216
  ds_read_b64_tr_b16 v[142:143], v6 offset:9984
  v_mfma_f32_32x32x16_bf16 v[48:63], v[156:159], v[132:135], v[48:63]
  ds_read_b64_tr_b16 v[144:145], v6 offset:9280
  ds_read_b64_tr_b16 v[146:147], v6 offset:10048
  ds_read_b64_tr_b16 v[148:149], v6 offset:9344
  ds_read_b64_tr_b16 v[150:151], v6 offset:10112
  v_mfma_f32_32x32x16_bf16 v[64:79], v[160:163], v[132:135], v[64:79]
  s_waitcnt lgkmcnt(7)
  v_mfma_f32_32x32x16_bf16 v[32:47], v[164:167], v[136:139], v[32:47]
  s_barrier
  ds_read_b128 v[132:135], v180 offset:0
  ds_read_b64_tr_b16 v[152:153], v6 offset:12288
  ds_read_b64_tr_b16 v[154:155], v6 offset:13056
  v_mfma_f32_32x32x16_bf16 v[48:63], v[168:171], v[136:139], v[48:63]
  ds_read_b64_tr_b16 v[156:157], v6 offset:12352
  ds_read_b64_tr_b16 v[158:159], v6 offset:13120
  ds_read_b64_tr_b16 v[160:161], v6 offset:12416
  ds_read_b64_tr_b16 v[162:163], v6 offset:13184
  v_mfma_f32_32x32x16_bf16 v[64:79], v[172:175], v[136:139], v[64:79]
  s_waitcnt lgkmcnt(7)
  v_mfma_f32_32x32x16_bf16 v[32:47], v[140:143], v[128:131], v[32:47]
  ds_read_b128 v[136:139], v181 offset:0
  ds_read_b64_tr_b16 v[164:165], v6 offset:15360
  ds_read_b64_tr_b16 v[166:167], v6 offset:16128
  v_mfma_f32_32x32x16_bf16 v[48:63], v[144:147], v[128:131], v[48:63]
  ds_read_b64_tr_b16 v[168:169], v6 offset:15424
  ds_read_b64_tr_b16 v[170:171], v6 offset:16192
  ds_read_b64_tr_b16 v[172:173], v6 offset:15488
  ds_read_b64_tr_b16 v[174:175], v6 offset:16256
  v_mfma_f32_32x32x16_bf16 v[64:79], v[148:151], v[128:131], v[64:79]
  s_waitcnt lgkmcnt(7)
  v_mfma_f32_32x32x16_bf16 v[32:47], v[152:155], v[132:135], v[32:47]
  s_barrier
  ds_read_b128 v[128:131], v182 offset:0
  ds_read_b64_tr_b16 v[140:141], v6 offset:18432
  ds_read_b64_tr_b16 v[142:143], v6 offset:19200
  v_mfma_f32_32x32x16_bf16 v[48:63], v[156:159], v[132:135], v[48:63]
  ds_read_b64_tr_b16 v[144:145], v6 offset:18496
  ds_read_b64_tr_b16 v[146:147], v6 offset:19264
  ds_read_b64_tr_b16 v[148:149], v6 offset:18560
  ds_read_b64_tr_b16 v[150:151], v6 offset:19328
  v_mfma_f32_32x32x16_bf16 v[64:79], v[160:163], v[132:135], v[64:79]
  s_waitcnt lgkmcnt(7)
  v_mfma_f32_32x32x16_bf16 v[32:47], v[164:167], v[136:139], v[32:47]
  ds_read_b128 v[132:135], v183 offset:0
  ds_read_b64_tr_b16 v[152:153], v6 offset:21504
  ds_read_b64_tr_b16 v[154:155], v6 offset:22272
  v_mfma_f32_32x32x16_bf16 v[48:63], v[168:171], v[136:139], v[48:63]
  ds_read_b64_tr_b16 v[156:157], v6 offset:21568
  ds_read_b64_tr_b16 v[158:159], v6 offset:22336
  ds_read_b64_tr_b16 v[160:161], v6 offset:21632
  ds_read_b64_tr_b16 v[162:163], v6 offset:22400
  v_mfma_f32_32x32x16_bf16 v[64:79], v[172:175], v[136:139], v[64:79]
  s_waitcnt lgkmcnt(7)
  v_mfma_f32_32x32x16_bf16 v[32:47], v[140:143], v[128:131], v[32:47]
  s_barrier
  ds_read_b128 v[136:139], v180 offset:16384
  ds_read_b64_tr_b16 v[164:165], v6 offset:24576
  ds_read_b64_tr_b16 v[166:167], v6 offset:25344
  v_mfma_f32_32x32x16_bf16 v[48:63], v[144:147], v[128:131], v[48:63]
  ds_read_b64_tr_b16 v[168:169], v6 offset:24640
  ds_read_b64_tr_b16 v[170:171], v6 offset:25408
  ds_read_b64_tr_b16 v[172:173], v6 offset:24704
  ds_read_b64_tr_b16 v[174:175], v6 offset:25472
  v_mfma_f32_32x32x16_bf16 v[64:79], v[148:151], v[128:131], v[64:79]
  s_waitcnt lgkmcnt(7)
  v_mfma_f32_32x32x16_bf16 v[32:47], v[152:155], v[132:135], v[32:47]
  ds_read_b128 v[128:131], v181 offset:16384
  ds_read_b64_tr_b16 v[140:141], v6 offset:27648
  ds_read_b64_tr_b16 v[142:143], v6 offset:28416
  v_mfma_f32_32x32x16_bf16 v[48:63], v[156:159], v[132:135], v[48:63]
  ds_read_b64_tr_b16 v[144:145], v6 offset:27712
  ds_read_b64_tr_b16 v[146:147], v6 offset:28480
  ds_read_b64_tr_b16 v[148:149], v6 offset:27776
  ds_read_b64_tr_b16 v[150:151], v6 offset:28544
  v_mfma_f32_32x32x16_bf16 v[64:79], v[160:163], v[132:135], v[64:79]
  s_waitcnt lgkmcnt(7)
  v_mfma_f32_32x32x16_bf16 v[32:47], v[164:167], v[136:139], v[32:47]
  s_barrier
  ds_read_b128 v[132:135], v182 offset:16384
  ds_read_b64_tr_b16 v[152:153], v6 offset:30720
  ds_read_b64_tr_b16 v[154:155], v6 offset:31488
  v_mfma_f32_32x32x16_bf16 v[48:63], v[168:171], v[136:139], v[48:63]
  ds_read_b64_tr_b16 v[156:157], v6 offset:30784
  ds_read_b64_tr_b16 v[158:159], v6 offset:31552
  ds_read_b64_tr_b16 v[160:161], v6 offset:30848
  ds_read_b64_tr_b16 v[162:163], v6 offset:31616
  v_mfma_f32_32x32x16_bf16 v[64:79], v[172:175], v[136:139], v[64:79]
  s_waitcnt lgkmcnt(7)
  v_mfma_f32_32x32x16_bf16 v[32:47], v[140:143], v[128:131], v[32:47]
  ds_read_b128 v[136:139], v183 offset:16384
  ds_read_b64_tr_b16 v[164:165], v6 offset:33792
  ds_read_b64_tr_b16 v[166:167], v6 offset:34560
  v_mfma_f32_32x32x16_bf16 v[48:63], v[144:147], v[128:131], v[48:63]
  ds_read_b64_tr_b16 v[168:169], v6 offset:33856
  ds_read_b64_tr_b16 v[170:171], v6 offset:34624
  ds_read_b64_tr_b16 v[172:173], v6 offset:33920
  ds_read_b64_tr_b16 v[174:175], v6 offset:34688
  v_mfma_f32_32x32x16_bf16 v[64:79], v[148:151], v[128:131], v[64:79]
  s_waitcnt lgkmcnt(7)
  v_mfma_f32_32x32x16_bf16 v[32:47], v[152:155], v[132:135], v[32:47]
  s_barrier
  ds_read_b128 v[128:131], v2 offset:0
  ds_read_b64_tr_b16 v[140:141], v6 offset:0
  ds_read_b64_tr_b16 v[142:143], v6 offset:768
  v_mfma_f32_32x32x16_bf16 v[48:63], v[156:159], v[132:135], v[48:63]
  ds_read_b64_tr_b16 v[144:145], v6 offset:64
  ds_read_b64_tr_b16 v[146:147], v6 offset:832
  ds_read_b64_tr_b16 v[148:149], v6 offset:128
  ds_read_b64_tr_b16 v[150:151], v6 offset:896
  v_mfma_f32_32x32x16_bf16 v[64:79], v[160:163], v[132:135], v[64:79]
  s_waitcnt lgkmcnt(7)
  v_mfma_f32_32x32x16_bf16 v[32:47], v[164:167], v[136:139], v[32:47]
  ds_read_b128 v[132:135], v3 offset:0
  ds_read_b64_tr_b16 v[152:153], v6 offset:3072
  ds_read_b64_tr_b16 v[154:155], v6 offset:3840
  v_mfma_f32_32x32x16_bf16 v[48:63], v[168:171], v[136:139], v[48:63]
  ds_read_b64_tr_b16 v[156:157], v6 offset:3136
  ds_read_b64_tr_b16 v[158:159], v6 offset:3904
  ds_read_b64_tr_b16 v[160:161], v6 offset:3200
  ds_read_b64_tr_b16 v[162:163], v6 offset:3968
  v_mfma_f32_32x32x16_bf16 v[64:79], v[172:175], v[136:139], v[64:79]
  s_waitcnt lgkmcnt(7)
  v_mfma_f32_32x32x16_bf16 v[32:47], v[140:143], v[128:131], v[32:47]
  s_barrier
  ds_read_b128 v[136:139], v4 offset:0
  ds_read_b64_tr_b16 v[164:165], v6 offset:6144
  ds_read_b64_tr_b16 v[166:167], v6 offset:6912
  v_mfma_f32_32x32x16_bf16 v[48:63], v[144:147], v[128:131], v[48:63]
  ds_read_b64_tr_b16 v[168:169], v6 offset:6208
  ds_read_b64_tr_b16 v[170:171], v6 offset:6976
  ds_read_b64_tr_b16 v[172:173], v6 offset:6272
  ds_read_b64_tr_b16 v[174:175], v6 offset:7040
  v_mfma_f32_32x32x16_bf16 v[64:79], v[148:151], v[128:131], v[64:79]
  s_waitcnt lgkmcnt(7)
  v_mfma_f32_32x32x16_bf16 v[32:47], v[152:155], v[132:135], v[32:47]
  ds_read_b128 v[128:131], v5 offset:0
  ds_read_b64_tr_b16 v[140:141], v6 offset:9216
  ds_read_b64_tr_b16 v[142:143], v6 offset:9984
  v_mfma_f32_32x32x16_bf16 v[48:63], v[156:159], v[132:135], v[48:63]
  ds_read_b64_tr_b16 v[144:145], v6 offset:9280
  ds_read_b64_tr_b16 v[146:147], v6 offset:10048
  ds_read_b64_tr_b16 v[148:149], v6 offset:9344
  ds_read_b64_tr_b16 v[150:151], v6 offset:10112
  v_mfma_f32_32x32x16_bf16 v[64:79], v[160:163], v[132:135], v[64:79]
  s_waitcnt lgkmcnt(7)
  v_mfma_f32_32x32x16_bf16 v[32:47], v[164:167], v[136:139], v[32:47]
  s_barrier
  ds_read_b128 v[132:135], v2 offset:16384
  ds_read_b64_tr_b16 v[152:153], v6 offset:12288
  ds_read_b64_tr_b16 v[154:155], v6 offset:13056
  v_mfma_f32_32x32x16_bf16 v[48:63], v[168:171], v[136:139], v[48:63]
  ds_read_b64_tr_b16 v[156:157], v6 offset:12352
  ds_read_b64_tr_b16 v[158:159], v6 offset:13120
  ds_read_b64_tr_b16 v[160:161], v6 offset:12416
  ds_read_b64_tr_b16 v[162:163], v6 offset:13184
  v_mfma_f32_32x32x16_bf16 v[64:79], v[172:175], v[136:139], v[64:79]
  s_waitcnt lgkmcnt(7)
  v_mfma_f32_32x32x16_bf16 v[32:47], v[140:143], v[128:131], v[32:47]
  ds_read_b128 v[136:139], v3 offset:16384
  ds_read_b64_tr_b16 v[164:165], v6 offset:15360
  ds_read_b64_tr_b16 v[166:167], v6 offset:16128
  v_mfma_f32_32x32x16_bf16 v[48:63], v[144:147], v[128:131], v[48:63]
  ds_read_b64_tr_b16 v[168:169], v6 offset:15424
  ds_read_b64_tr_b16 v[170:171], v6 offset:16192
  ds_read_b64_tr_b16 v[172:173], v6 offset:15488
  ds_read_b64_tr_b16 v[174:175], v6 offset:16256
  v_mfma_f32_32x32x16_bf16 v[64:79], v[148:151], v[128:131], v[64:79]
  s_waitcnt lgkmcnt(7)
  v_mfma_f32_32x32x16_bf16 v[32:47], v[152:155], v[132:135], v[32:47]
  s_barrier
  ds_read_b128 v[128:131], v4 offset:16384
  ds_read_b64_tr_b16 v[140:141], v6 offset:18432
  ds_read_b64_tr_b16 v[142:143], v6 offset:19200
  v_mfma_f32_32x32x16_bf16 v[48:63], v[156:159], v[132:135], v[48:63]
  ds_read_b64_tr_b16 v[144:145], v6 offset:18496
  ds_read_b64_tr_b16 v[146:147], v6 offset:19264
  ds_read_b64_tr_b16 v[148:149], v6 offset:18560
  ds_read_b64_tr_b16 v[150:151], v6 offset:19328
  v_mfma_f32_32x32x16_bf16 v[64:79], v[160:163], v[132:135], v[64:79]
  s_waitcnt lgkmcnt(7)
  v_mfma_f32_32x32x16_bf16 v[32:47], v[164:167], v[136:139], v[32:47]
  ds_read_b128 v[132:135], v5 offset:16384
  ds_read_b64_tr_b16 v[152:153], v6 offset:21504
  ds_read_b64_tr_b16 v[154:155], v6 offset:22272
  v_mfma_f32_32x32x16_bf16 v[48:63], v[168:171], v[136:139], v[48:63]
  ds_read_b64_tr_b16 v[156:157], v6 offset:21568
  ds_read_b64_tr_b16 v[158:159], v6 offset:22336
  ds_read_b64_tr_b16 v[160:161], v6 offset:21632
  ds_read_b64_tr_b16 v[162:163], v6 offset:22400
  v_mfma_f32_32x32x16_bf16 v[64:79], v[172:175], v[136:139], v[64:79]
  s_waitcnt lgkmcnt(7)
  v_mfma_f32_32x32x16_bf16 v[32:47], v[140:143], v[128:131], v[32:47]
  s_barrier
  ds_read_b128 v[136:139], v2 offset:32768
  ds_read_b64_tr_b16 v[164:165], v6 offset:24576
  ds_read_b64_tr_b16 v[166:167], v6 offset:25344
  v_mfma_f32_32x32x16_bf16 v[48:63], v[144:147], v[128:131], v[48:63]
  ds_read_b64_tr_b16 v[168:169], v6 offset:24640
  ds_read_b64_tr_b16 v[170:171], v6 offset:25408
  ds_read_b64_tr_b16 v[172:173], v6 offset:24704
  ds_read_b64_tr_b16 v[174:175], v6 offset:25472
  v_mfma_f32_32x32x16_bf16 v[64:79], v[148:151], v[128:131], v[64:79]
  s_waitcnt lgkmcnt(7)
  v_mfma_f32_32x32x16_bf16 v[32:47], v[152:155], v[132:135], v[32:47]
  ds_read_b128 v[128:131], v3 offset:32768
  ds_read_b64_tr_b16 v[140:141], v6 offset:27648
  ds_read_b64_tr_b16 v[142:143], v6 offset:28416
  v_mfma_f32_32x32x16_bf16 v[48:63], v[156:159], v[132:135], v[48:63]
  ds_read_b64_tr_b16 v[144:145], v6 offset:27712
  ds_read_b64_tr_b16 v[146:147], v6 offset:28480
  ds_read_b64_tr_b16 v[148:149], v6 offset:27776
  ds_read_b64_tr_b16 v[150:151], v6 offset:28544
  v_mfma_f32_32x32x16_bf16 v[64:79], v[160:163], v[132:135], v[64:79]
  s_waitcnt lgkmcnt(7)
  v_mfma_f32_32x32x16_bf16 v[80:95], v[164:167], v[136:139], 0
  s_barrier
  ds_read_b128 v[132:135], v4 offset:32768
  ds_read_b64_tr_b16 v[152:153], v6 offset:30720
  ds_read_b64_tr_b16 v[154:155], v6 offset:31488
  v_mfma_f32_32x32x16_bf16 v[96:111], v[168:171], v[136:139], 0
  ds_read_b64_tr_b16 v[156:157], v6 offset:30784
  ds_read_b64_tr_b16 v[158:159], v6 offset:31552
  ds_read_b64_tr_b16 v[160:161], v6 offset:30848
  ds_read_b64_tr_b16 v[162:163], v6 offset:31616
  v_mfma_f32_32x32x16_bf16 v[112:127], v[172:175], v[136:139], 0
  s_waitcnt lgkmcnt(7)
  v_mfma_f32_32x32x16_bf16 v[80:95], v[140:143], v[128:131], v[80:95]
  ds_read_b128 v[136:139], v5 offset:32768
  ds_read_b64_tr_b16 v[164:165], v6 offset:33792
  ds_read_b64_tr_b16 v[166:167], v6 offset:34560
  v_mfma_f32_32x32x16_bf16 v[96:111], v[144:147], v[128:131], v[96:111]
  ds_read_b64_tr_b16 v[168:169], v6 offset:33856
  ds_read_b64_tr_b16 v[170:171], v6 offset:34624
  ds_read_b64_tr_b16 v[172:173], v6 offset:33920
  ds_read_b64_tr_b16 v[174:175], v6 offset:34688
  v_mfma_f32_32x32x16_bf16 v[112:127], v[148:151], v[128:131], v[112:127]
  s_lshl_b32 s46, s26, 9
  s_add_u32 s46, s46, 160256
  v_lshlrev_b32 v7, 4, v14
  v_add_u32 v7, s46, v7
  ds_read_b128 v[16:19], v7
  v_lshlrev_b32 v7, 4, v15
  v_add_u32 v7, 162304, v7
  ds_read_b128 v[184:187], v7 offset:0
  ds_read_b128 v[188:191], v7 offset:32
  ds_read_b128 v[192:195], v7 offset:64
  ds_read_b128 v[196:199], v7 offset:96
  ds_read_b128 v[200:203], v7 offset:128
  ds_read_b128 v[204:207], v7 offset:160
  ds_read_b128 v[208:211], v7 offset:192
  ds_read_b128 v[212:215], v7 offset:224
  ds_read_b128 v[216:219], v7 offset:256
  ds_read_b128 v[220:223], v7 offset:288
  ds_read_b128 v[224:227], v7 offset:320
  ds_read_b128 v[228:231], v7 offset:352
  s_waitcnt lgkmcnt(0)
  v_mul_f32 v10, s36, v16
  v_mul_f32 v11, s36, v17
  v_pk_mul_f32 v[24:25], v[184:185], v[10:11] op_sel:[0,1] op_sel_hi:[1,1]
  v_pk_mul_f32 v[26:27], v[186:187], v[10:11] op_sel:[0,1] op_sel_hi:[1,1]
  v_pk_mul_f32 v[28:29], v[188:189], v[10:11] op_sel:[0,1] op_sel_hi:[1,1]
  v_pk_mul_f32 v[30:31], v[190:191], v[10:11] op_sel:[0,1] op_sel_hi:[1,1]
  v_pk_fma_f32 v[32:33], v[32:33], v[10:11], v[24:25] op_sel_hi:[1,0,1] neg_lo:[0,0,1] neg_hi:[0,0,1]
  v_pk_fma_f32 v[34:35], v[34:35], v[10:11], v[26:27] op_sel_hi:[1,0,1] neg_lo:[0,0,1] neg_hi:[0,0,1]
  v_pk_fma_f32 v[36:37], v[36:37], v[10:11], v[28:29] op_sel_hi:[1,0,1] neg_lo:[0,0,1] neg_hi:[0,0,1]
  v_pk_fma_f32 v[38:39], v[38:39], v[10:11], v[30:31] op_sel_hi:[1,0,1] neg_lo:[0,0,1] neg_hi:[0,0,1]
  v_cvt_pk_bf16_f32 v232, v32, v33
  v_cvt_pk_bf16_f32 v233, v34, v35
  v_cvt_pk_bf16_f32 v234, v36, v37
  v_cvt_pk_bf16_f32 v235, v38, v39
  s_add_u32 s62, s40, 0
  buffer_store_dwordx4 v[232:235], v20, s[32:35], s62 offen sc1
  v_pk_mul_f32 v[24:25], v[192:193], v[10:11] op_sel:[0,1] op_sel_hi:[1,1]
  v_pk_mul_f32 v[26:27], v[194:195], v[10:11] op_sel:[0,1] op_sel_hi:[1,1]
  v_pk_mul_f32 v[28:29], v[196:197], v[10:11] op_sel:[0,1] op_sel_hi:[1,1]
  v_pk_mul_f32 v[30:31], v[198:199], v[10:11] op_sel:[0,1] op_sel_hi:[1,1]
  v_pk_fma_f32 v[40:41], v[40:41], v[10:11], v[24:25] op_sel_hi:[1,0,1] neg_lo:[0,0,1] neg_hi:[0,0,1]
  v_pk_fma_f32 v[42:43], v[42:43], v[10:11], v[26:27] op_sel_hi:[1,0,1] neg_lo:[0,0,1] neg_hi:[0,0,1]
  v_pk_fma_f32 v[44:45], v[44:45], v[10:11], v[28:29] op_sel_hi:[1,0,1] neg_lo:[0,0,1] neg_hi:[0,0,1]
  v_pk_fma_f32 v[46:47], v[46:47], v[10:11], v[30:31] op_sel_hi:[1,0,1] neg_lo:[0,0,1] neg_hi:[0,0,1]
  v_cvt_pk_bf16_f32 v236, v40, v41
  v_cvt_pk_bf16_f32 v237, v42, v43
  v_cvt_pk_bf16_f32 v238, v44, v45
  v_cvt_pk_bf16_f32 v239, v46, v47
  s_add_u32 s62, s40, 65536
  buffer_store_dwordx4 v[236:239], v20, s[32:35], s62 offen sc1
  v_mul_f32 v10, s37, v16
  v_mul_f32 v11, s37, v17
  v_pk_mul_f32 v[24:25], v[200:201], v[10:11] op_sel:[0,1] op_sel_hi:[1,1]
  v_pk_mul_f32 v[26:27], v[202:203], v[10:11] op_sel:[0,1] op_sel_hi:[1,1]
  v_pk_mul_f32 v[28:29], v[204:205], v[10:11] op_sel:[0,1] op_sel_hi:[1,1]
  v_pk_mul_f32 v[30:31], v[206:207], v[10:11] op_sel:[0,1] op_sel_hi:[1,1]
  v_pk_fma_f32 v[48:49], v[48:49], v[10:11], v[24:25] op_sel_hi:[1,0,1] neg_lo:[0,0,1] neg_hi:[0,0,1]
  v_pk_fma_f32 v[50:51], v[50:51], v[10:11], v[26:27] op_sel_hi:[1,0,1] neg_lo:[0,0,1] neg_hi:[0,0,1]
  v_pk_fma_f32 v[52:53], v[52:53], v[10:11], v[28:29] op_sel_hi:[1,0,1] neg_lo:[0,0,1] neg_hi:[0,0,1]
  v_pk_fma_f32 v[54:55], v[54:55], v[10:11], v[30:31] op_sel_hi:[1,0,1] neg_lo:[0,0,1] neg_hi:[0,0,1]
  v_cvt_pk_bf16_f32 v240, v48, v49
  v_cvt_pk_bf16_f32 v241, v50, v51
  v_cvt_pk_bf16_f32 v242, v52, v53
  v_cvt_pk_bf16_f32 v243, v54, v55
  s_add_u32 s62, s41, 0
  buffer_store_dwordx4 v[240:243], v21, s[32:35], s62 offen sc1
  v_pk_mul_f32 v[24:25], v[208:209], v[10:11] op_sel:[0,1] op_sel_hi:[1,1]
  v_pk_mul_f32 v[26:27], v[210:211], v[10:11] op_sel:[0,1] op_sel_hi:[1,1]
  v_pk_mul_f32 v[28:29], v[212:213], v[10:11] op_sel:[0,1] op_sel_hi:[1,1]
  v_pk_mul_f32 v[30:31], v[214:215], v[10:11] op_sel:[0,1] op_sel_hi:[1,1]
  v_pk_fma_f32 v[56:57], v[56:57], v[10:11], v[24:25] op_sel_hi:[1,0,1] neg_lo:[0,0,1] neg_hi:[0,0,1]
  v_pk_fma_f32 v[58:59], v[58:59], v[10:11], v[26:27] op_sel_hi:[1,0,1] neg_lo:[0,0,1] neg_hi:[0,0,1]
  v_pk_fma_f32 v[60:61], v[60:61], v[10:11], v[28:29] op_sel_hi:[1,0,1] neg_lo:[0,0,1] neg_hi:[0,0,1]
  v_pk_fma_f32 v[62:63], v[62:63], v[10:11], v[30:31] op_sel_hi:[1,0,1] neg_lo:[0,0,1] neg_hi:[0,0,1]
  v_cvt_pk_bf16_f32 v244, v56, v57
  v_cvt_pk_bf16_f32 v245, v58, v59
  v_cvt_pk_bf16_f32 v246, v60, v61
  v_cvt_pk_bf16_f32 v247, v62, v63
  s_add_u32 s62, s41, 65536
  buffer_store_dwordx4 v[244:247], v21, s[32:35], s62 offen sc1
  v_mul_f32 v10, s38, v16
  v_mul_f32 v11, s38, v17
  v_pk_mul_f32 v[24:25], v[216:217], v[10:11] op_sel:[0,1] op_sel_hi:[1,1]
  v_pk_mul_f32 v[26:27], v[218:219], v[10:11] op_sel:[0,1] op_sel_hi:[1,1]
  v_pk_mul_f32 v[28:29], v[220:221], v[10:11] op_sel:[0,1] op_sel_hi:[1,1]
  v_pk_mul_f32 v[30:31], v[222:223], v[10:11] op_sel:[0,1] op_sel_hi:[1,1]
  v_pk_fma_f32 v[64:65], v[64:65], v[10:11], v[24:25] op_sel_hi:[1,0,1] neg_lo:[0,0,1] neg_hi:[0,0,1]
  v_pk_fma_f32 v[66:67], v[66:67], v[10:11], v[26:27] op_sel_hi:[1,0,1] neg_lo:[0,0,1] neg_hi:[0,0,1]
  v_pk_fma_f32 v[68:69], v[68:69], v[10:11], v[28:29] op_sel_hi:[1,0,1] neg_lo:[0,0,1] neg_hi:[0,0,1]
  v_pk_fma_f32 v[70:71], v[70:71], v[10:11], v[30:31] op_sel_hi:[1,0,1] neg_lo:[0,0,1] neg_hi:[0,0,1]
  v_cvt_pk_bf16_f32 v232, v64, v65
  v_cvt_pk_bf16_f32 v233, v66, v67
  v_cvt_pk_bf16_f32 v234, v68, v69
  v_cvt_pk_bf16_f32 v235, v70, v71
  s_add_u32 s62, s42, 0
  buffer_store_dwordx4 v[232:235], v22, s[32:35], s62 offen sc1
  v_pk_mul_f32 v[24:25], v[224:225], v[10:11] op_sel:[0,1] op_sel_hi:[1,1]
  v_pk_mul_f32 v[26:27], v[226:227], v[10:11] op_sel:[0,1] op_sel_hi:[1,1]
  v_pk_mul_f32 v[28:29], v[228:229], v[10:11] op_sel:[0,1] op_sel_hi:[1,1]
  v_pk_mul_f32 v[30:31], v[230:231], v[10:11] op_sel:[0,1] op_sel_hi:[1,1]
  v_pk_fma_f32 v[72:73], v[72:73], v[10:11], v[24:25] op_sel_hi:[1,0,1] neg_lo:[0,0,1] neg_hi:[0,0,1]
  v_pk_fma_f32 v[74:75], v[74:75], v[10:11], v[26:27] op_sel_hi:[1,0,1] neg_lo:[0,0,1] neg_hi:[0,0,1]
  v_pk_fma_f32 v[76:77], v[76:77], v[10:11], v[28:29] op_sel_hi:[1,0,1] neg_lo:[0,0,1] neg_hi:[0,0,1]
  v_pk_fma_f32 v[78:79], v[78:79], v[10:11], v[30:31] op_sel_hi:[1,0,1] neg_lo:[0,0,1] neg_hi:[0,0,1]
  v_cvt_pk_bf16_f32 v236, v72, v73
  v_cvt_pk_bf16_f32 v237, v74, v75
  v_cvt_pk_bf16_f32 v238, v76, v77
  v_cvt_pk_bf16_f32 v239, v78, v79
  s_add_u32 s62, s42, 65536
  buffer_store_dwordx4 v[236:239], v22, s[32:35], s62 offen sc1
  s_nop 1
  s_waitcnt lgkmcnt(0)
  v_mfma_f32_32x32x16_bf16 v[80:95], v[152:155], v[132:135], v[80:95]
  s_barrier
  ds_read_b128 v[128:131], v2 offset:49152
  ds_read_b64_tr_b16 v[140:141], v6 offset:0
  ds_read_b64_tr_b16 v[142:143], v6 offset:768
  v_mfma_f32_32x32x16_bf16 v[96:111], v[156:159], v[132:135], v[96:111]
  ds_read_b64_tr_b16 v[144:145], v6 offset:64
  ds_read_b64_tr_b16 v[146:147], v6 offset:832
  ds_read_b64_tr_b16 v[148:149], v6 offset:128
  ds_read_b64_tr_b16 v[150:151], v6 offset:896
  v_mfma_f32_32x32x16_bf16 v[112:127], v[160:163], v[132:135], v[112:127]
  s_waitcnt lgkmcnt(7)
  v_mfma_f32_32x32x16_bf16 v[80:95], v[164:167], v[136:139], v[80:95]
  ds_read_b128 v[132:135], v3 offset:49152
  ds_read_b64_tr_b16 v[152:153], v6 offset:3072
  ds_read_b64_tr_b16 v[154:155], v6 offset:3840
  v_mfma_f32_32x32x16_bf16 v[96:111], v[168:171], v[136:139], v[96:111]
  ds_read_b64_tr_b16 v[156:157], v6 offset:3136
  ds_read_b64_tr_b16 v[158:159], v6 offset:3904
  ds_read_b64_tr_b16 v[160:161], v6 offset:3200
  ds_read_b64_tr_b16 v[162:163], v6 offset:3968
  v_mfma_f32_32x32x16_bf16 v[112:127], v[172:175], v[136:139], v[112:127]
  s_waitcnt lgkmcnt(7)
  v_mfma_f32_32x32x16_bf16 v[80:95], v[140:143], v[128:131], v[80:95]
  s_barrier
  ds_read_b128 v[136:139], v4 offset:49152
  ds_read_b64_tr_b16 v[164:165], v6 offset:6144
  ds_read_b64_tr_b16 v[166:167], v6 offset:6912
  v_mfma_f32_32x32x16_bf16 v[96:111], v[144:147], v[128:131], v[96:111]
  ds_read_b64_tr_b16 v[168:169], v6 offset:6208
  ds_read_b64_tr_b16 v[170:171], v6 offset:6976
  ds_read_b64_tr_b16 v[172:173], v6 offset:6272
  ds_read_b64_tr_b16 v[174:175], v6 offset:7040
  v_mfma_f32_32x32x16_bf16 v[112:127], v[148:151], v[128:131], v[112:127]
  s_waitcnt lgkmcnt(7)
  v_mfma_f32_32x32x16_bf16 v[80:95], v[152:155], v[132:135], v[80:95]
  ds_read_b128 v[128:131], v5 offset:49152
  ds_read_b64_tr_b16 v[140:141], v6 offset:9216
  ds_read_b64_tr_b16 v[142:143], v6 offset:9984
  v_mfma_f32_32x32x16_bf16 v[96:111], v[156:159], v[132:135], v[96:111]
  ds_read_b64_tr_b16 v[144:145], v6 offset:9280
  ds_read_b64_tr_b16 v[146:147], v6 offset:10048
  ds_read_b64_tr_b16 v[148:149], v6 offset:9344
  ds_read_b64_tr_b16 v[150:151], v6 offset:10112
  v_mfma_f32_32x32x16_bf16 v[112:127], v[160:163], v[132:135], v[112:127]
  s_waitcnt lgkmcnt(7)
  v_mfma_f32_32x32x16_bf16 v[80:95], v[164:167], v[136:139], v[80:95]
  s_barrier
  ds_read_b128 v[132:135], v180 offset:0
  ds_read_b64_tr_b16 v[152:153], v6 offset:12288
  ds_read_b64_tr_b16 v[154:155], v6 offset:13056
  v_mfma_f32_32x32x16_bf16 v[96:111], v[168:171], v[136:139], v[96:111]
  ds_read_b64_tr_b16 v[156:157], v6 offset:12352
  ds_read_b64_tr_b16 v[158:159], v6 offset:13120
  ds_read_b64_tr_b16 v[160:161], v6 offset:12416
  ds_read_b64_tr_b16 v[162:163], v6 offset:13184
  v_mfma_f32_32x32x16_bf16 v[112:127], v[172:175], v[136:139], v[112:127]
  s_waitcnt lgkmcnt(7)
  v_mfma_f32_32x32x16_bf16 v[80:95], v[140:143], v[128:131], v[80:95]
  ds_read_b128 v[136:139], v181 offset:0
  ds_read_b64_tr_b16 v[164:165], v6 offset:15360
  ds_read_b64_tr_b16 v[166:167], v6 offset:16128
  v_mfma_f32_32x32x16_bf16 v[96:111], v[144:147], v[128:131], v[96:111]
  ds_read_b64_tr_b16 v[168:169], v6 offset:15424
  ds_read_b64_tr_b16 v[170:171], v6 offset:16192
  ds_read_b64_tr_b16 v[172:173], v6 offset:15488
  ds_read_b64_tr_b16 v[174:175], v6 offset:16256
  v_mfma_f32_32x32x16_bf16 v[112:127], v[148:151], v[128:131], v[112:127]
  s_waitcnt lgkmcnt(7)
  v_mfma_f32_32x32x16_bf16 v[80:95], v[152:155], v[132:135], v[80:95]
  s_barrier
  ds_read_b128 v[128:131], v182 offset:0
  ds_read_b64_tr_b16 v[140:141], v6 offset:18432
  ds_read_b64_tr_b16 v[142:143], v6 offset:19200
  v_mfma_f32_32x32x16_bf16 v[96:111], v[156:159], v[132:135], v[96:111]
  ds_read_b64_tr_b16 v[144:145], v6 offset:18496
  ds_read_b64_tr_b16 v[146:147], v6 offset:19264
  ds_read_b64_tr_b16 v[148:149], v6 offset:18560
  ds_read_b64_tr_b16 v[150:151], v6 offset:19328
  v_mfma_f32_32x32x16_bf16 v[112:127], v[160:163], v[132:135], v[112:127]
  s_waitcnt lgkmcnt(7)
  v_mfma_f32_32x32x16_bf16 v[80:95], v[164:167], v[136:139], v[80:95]
  ds_read_b128 v[132:135], v183 offset:0
  ds_read_b64_tr_b16 v[152:153], v6 offset:21504
  ds_read_b64_tr_b16 v[154:155], v6 offset:22272
  v_mfma_f32_32x32x16_bf16 v[96:111], v[168:171], v[136:139], v[96:111]
  ds_read_b64_tr_b16 v[156:157], v6 offset:21568
  ds_read_b64_tr_b16 v[158:159], v6 offset:22336
  ds_read_b64_tr_b16 v[160:161], v6 offset:21632
  ds_read_b64_tr_b16 v[162:163], v6 offset:22400
  v_mfma_f32_32x32x16_bf16 v[112:127], v[172:175], v[136:139], v[112:127]
  s_waitcnt lgkmcnt(7)
  v_mfma_f32_32x32x16_bf16 v[80:95], v[140:143], v[128:131], v[80:95]
  s_barrier
  ds_read_b128 v[136:139], v180 offset:16384
  ds_read_b64_tr_b16 v[164:165], v6 offset:24576
  ds_read_b64_tr_b16 v[166:167], v6 offset:25344
  v_mfma_f32_32x32x16_bf16 v[96:111], v[144:147], v[128:131], v[96:111]
  ds_read_b64_tr_b16 v[168:169], v6 offset:24640
  ds_read_b64_tr_b16 v[170:171], v6 offset:25408
  ds_read_b64_tr_b16 v[172:173], v6 offset:24704
  ds_read_b64_tr_b16 v[174:175], v6 offset:25472
  v_mfma_f32_32x32x16_bf16 v[112:127], v[148:151], v[128:131], v[112:127]
  s_waitcnt lgkmcnt(7)
  v_mfma_f32_32x32x16_bf16 v[80:95], v[152:155], v[132:135], v[80:95]
  ds_read_b128 v[128:131], v181 offset:16384
  ds_read_b64_tr_b16 v[140:141], v6 offset:27648
  ds_read_b64_tr_b16 v[142:143], v6 offset:28416
  v_mfma_f32_32x32x16_bf16 v[96:111], v[156:159], v[132:135], v[96:111]
  ds_read_b64_tr_b16 v[144:145], v6 offset:27712
  ds_read_b64_tr_b16 v[146:147], v6 offset:28480
  ds_read_b64_tr_b16 v[148:149], v6 offset:27776
  ds_read_b64_tr_b16 v[150:151], v6 offset:28544
  v_mfma_f32_32x32x16_bf16 v[112:127], v[160:163], v[132:135], v[112:127]
  s_waitcnt lgkmcnt(7)
  v_mfma_f32_32x32x16_bf16 v[80:95], v[164:167], v[136:139], v[80:95]
  s_barrier
  ds_read_b128 v[132:135], v182 offset:16384
  ds_read_b64_tr_b16 v[152:153], v6 offset:30720
  ds_read_b64_tr_b16 v[154:155], v6 offset:31488
  v_mfma_f32_32x32x16_bf16 v[96:111], v[168:171], v[136:139], v[96:111]
  ds_read_b64_tr_b16 v[156:157], v6 offset:30784
  ds_read_b64_tr_b16 v[158:159], v6 offset:31552
  ds_read_b64_tr_b16 v[160:161], v6 offset:30848
  ds_read_b64_tr_b16 v[162:163], v6 offset:31616
  v_mfma_f32_32x32x16_bf16 v[112:127], v[172:175], v[136:139], v[112:127]
  s_waitcnt lgkmcnt(7)
  v_mfma_f32_32x32x16_bf16 v[80:95], v[140:143], v[128:131], v[80:95]
  ds_read_b128 v[136:139], v183 offset:16384
  ds_read_b64_tr_b16 v[164:165], v6 offset:33792
  ds_read_b64_tr_b16 v[166:167], v6 offset:34560
  v_mfma_f32_32x32x16_bf16 v[96:111], v[144:147], v[128:131], v[96:111]
  ds_read_b64_tr_b16 v[168:169], v6 offset:33856
  ds_read_b64_tr_b16 v[170:171], v6 offset:34624
  ds_read_b64_tr_b16 v[172:173], v6 offset:33920
  ds_read_b64_tr_b16 v[174:175], v6 offset:34688
  v_mfma_f32_32x32x16_bf16 v[112:127], v[148:151], v[128:131], v[112:127]
  s_waitcnt lgkmcnt(7)
  v_mfma_f32_32x32x16_bf16 v[80:95], v[152:155], v[132:135], v[80:95]
  s_barrier
  ds_read_b128 v[128:131], v2 offset:0
  ds_read_b64_tr_b16 v[140:141], v6 offset:0
  ds_read_b64_tr_b16 v[142:143], v6 offset:768
  v_mfma_f32_32x32x16_bf16 v[96:111], v[156:159], v[132:135], v[96:111]
  ds_read_b64_tr_b16 v[144:145], v6 offset:64
  ds_read_b64_tr_b16 v[146:147], v6 offset:832
  ds_read_b64_tr_b16 v[148:149], v6 offset:128
  ds_read_b64_tr_b16 v[150:151], v6 offset:896
  v_mfma_f32_32x32x16_bf16 v[112:127], v[160:163], v[132:135], v[112:127]
  s_waitcnt lgkmcnt(7)
  v_mfma_f32_32x32x16_bf16 v[80:95], v[164:167], v[136:139], v[80:95]
  ds_read_b128 v[132:135], v3 offset:0
  ds_read_b64_tr_b16 v[152:153], v6 offset:3072
  ds_read_b64_tr_b16 v[154:155], v6 offset:3840
  v_mfma_f32_32x32x16_bf16 v[96:111], v[168:171], v[136:139], v[96:111]
  ds_read_b64_tr_b16 v[156:157], v6 offset:3136
  ds_read_b64_tr_b16 v[158:159], v6 offset:3904
  ds_read_b64_tr_b16 v[160:161], v6 offset:3200
  ds_read_b64_tr_b16 v[162:163], v6 offset:3968
  v_mfma_f32_32x32x16_bf16 v[112:127], v[172:175], v[136:139], v[112:127]
  s_waitcnt lgkmcnt(7)
  v_mfma_f32_32x32x16_bf16 v[80:95], v[140:143], v[128:131], v[80:95]
  s_barrier
  ds_read_b128 v[136:139], v4 offset:0
  ds_read_b64_tr_b16 v[164:165], v6 offset:6144
  ds_read_b64_tr_b16 v[166:167], v6 offset:6912
  v_mfma_f32_32x32x16_bf16 v[96:111], v[144:147], v[128:131], v[96:111]
  ds_read_b64_tr_b16 v[168:169], v6 offset:6208
  ds_read_b64_tr_b16 v[170:171], v6 offset:6976
  ds_read_b64_tr_b16 v[172:173], v6 offset:6272
  ds_read_b64_tr_b16 v[174:175], v6 offset:7040
  v_mfma_f32_32x32x16_bf16 v[112:127], v[148:151], v[128:131], v[112:127]
  s_waitcnt lgkmcnt(7)
  v_mfma_f32_32x32x16_bf16 v[80:95], v[152:155], v[132:135], v[80:95]
  ds_read_b128 v[128:131], v5 offset:0
  ds_read_b64_tr_b16 v[140:141], v6 offset:9216
  ds_read_b64_tr_b16 v[142:143], v6 offset:9984
  v_mfma_f32_32x32x16_bf16 v[96:111], v[156:159], v[132:135], v[96:111]
  ds_read_b64_tr_b16 v[144:145], v6 offset:9280
  ds_read_b64_tr_b16 v[146:147], v6 offset:10048
  ds_read_b64_tr_b16 v[148:149], v6 offset:9344
  ds_read_b64_tr_b16 v[150:151], v6 offset:10112
  v_mfma_f32_32x32x16_bf16 v[112:127], v[160:163], v[132:135], v[112:127]
  s_waitcnt lgkmcnt(7)
  v_mfma_f32_32x32x16_bf16 v[80:95], v[164:167], v[136:139], v[80:95]
  s_waitcnt vmcnt(0)
  s_barrier
  ds_read_b128 v[132:135], v2 offset:16384
  ds_read_b64_tr_b16 v[152:153], v6 offset:12288
  ds_read_b64_tr_b16 v[154:155], v6 offset:13056
  v_mfma_f32_32x32x16_bf16 v[96:111], v[168:171], v[136:139], v[96:111]
  ds_read_b64_tr_b16 v[156:157], v6 offset:12352
  ds_read_b64_tr_b16 v[158:159], v6 offset:13120
  ds_read_b64_tr_b16 v[160:161], v6 offset:12416
  ds_read_b64_tr_b16 v[162:163], v6 offset:13184
  v_mfma_f32_32x32x16_bf16 v[112:127], v[172:175], v[136:139], v[112:127]
  s_waitcnt lgkmcnt(7)
  v_mfma_f32_32x32x16_bf16 v[80:95], v[140:143], v[128:131], v[80:95]
  ds_read_b128 v[136:139], v3 offset:16384
  ds_read_b64_tr_b16 v[164:165], v6 offset:15360
  ds_read_b64_tr_b16 v[166:167], v6 offset:16128
  v_mfma_f32_32x32x16_bf16 v[96:111], v[144:147], v[128:131], v[96:111]
  ds_read_b64_tr_b16 v[168:169], v6 offset:15424
  ds_read_b64_tr_b16 v[170:171], v6 offset:16192
  ds_read_b64_tr_b16 v[172:173], v6 offset:15488
  ds_read_b64_tr_b16 v[174:175], v6 offset:16256
  v_mfma_f32_32x32x16_bf16 v[112:127], v[148:151], v[128:131], v[112:127]
  s_waitcnt lgkmcnt(7)
  v_mfma_f32_32x32x16_bf16 v[80:95], v[152:155], v[132:135], v[80:95]
  s_barrier
  ds_read_b128 v[128:131], v4 offset:16384
  ds_read_b64_tr_b16 v[140:141], v6 offset:18432
  ds_read_b64_tr_b16 v[142:143], v6 offset:19200
  v_mfma_f32_32x32x16_bf16 v[96:111], v[156:159], v[132:135], v[96:111]
  ds_read_b64_tr_b16 v[144:145], v6 offset:18496
  ds_read_b64_tr_b16 v[146:147], v6 offset:19264
  ds_read_b64_tr_b16 v[148:149], v6 offset:18560
  ds_read_b64_tr_b16 v[150:151], v6 offset:19328
  v_mfma_f32_32x32x16_bf16 v[112:127], v[160:163], v[132:135], v[112:127]
  s_waitcnt lgkmcnt(7)
  v_mfma_f32_32x32x16_bf16 v[80:95], v[164:167], v[136:139], v[80:95]
  ds_read_b128 v[132:135], v5 offset:16384
  ds_read_b64_tr_b16 v[152:153], v6 offset:21504
  ds_read_b64_tr_b16 v[154:155], v6 offset:22272
  v_mfma_f32_32x32x16_bf16 v[96:111], v[168:171], v[136:139], v[96:111]
  ds_read_b64_tr_b16 v[156:157], v6 offset:21568
  ds_read_b64_tr_b16 v[158:159], v6 offset:22336
  ds_read_b64_tr_b16 v[160:161], v6 offset:21632
  ds_read_b64_tr_b16 v[162:163], v6 offset:22400
  v_mfma_f32_32x32x16_bf16 v[112:127], v[172:175], v[136:139], v[112:127]
  s_waitcnt lgkmcnt(7)
  v_mfma_f32_32x32x16_bf16 v[80:95], v[140:143], v[128:131], v[80:95]
  s_barrier
  ds_read_b128 v[136:139], v2 offset:32768
  ds_read_b64_tr_b16 v[164:165], v6 offset:24576
  ds_read_b64_tr_b16 v[166:167], v6 offset:25344
  v_mfma_f32_32x32x16_bf16 v[96:111], v[144:147], v[128:131], v[96:111]
  ds_read_b64_tr_b16 v[168:169], v6 offset:24640
  ds_read_b64_tr_b16 v[170:171], v6 offset:25408
  ds_read_b64_tr_b16 v[172:173], v6 offset:24704
  ds_read_b64_tr_b16 v[174:175], v6 offset:25472
  v_mfma_f32_32x32x16_bf16 v[112:127], v[148:151], v[128:131], v[112:127]
  s_waitcnt lgkmcnt(7)
  v_mfma_f32_32x32x16_bf16 v[80:95], v[152:155], v[132:135], v[80:95]
  ds_read_b128 v[128:131], v3 offset:32768
  ds_read_b64_tr_b16 v[140:141], v6 offset:27648
  ds_read_b64_tr_b16 v[142:143], v6 offset:28416
  v_mfma_f32_32x32x16_bf16 v[96:111], v[156:159], v[132:135], v[96:111]
  ds_read_b64_tr_b16 v[144:145], v6 offset:27712
  ds_read_b64_tr_b16 v[146:147], v6 offset:28480
  ds_read_b64_tr_b16 v[148:149], v6 offset:27776
  ds_read_b64_tr_b16 v[150:151], v6 offset:28544
  v_mfma_f32_32x32x16_bf16 v[112:127], v[160:163], v[132:135], v[112:127]
  s_waitcnt lgkmcnt(7)
  v_mfma_f32_32x32x16_bf16 v[80:95], v[164:167], v[136:139], v[80:95]
  s_barrier
  ds_read_b128 v[132:135], v4 offset:32768
  ds_read_b64_tr_b16 v[152:153], v6 offset:30720
  ds_read_b64_tr_b16 v[154:155], v6 offset:31488
  v_mfma_f32_32x32x16_bf16 v[96:111], v[168:171], v[136:139], v[96:111]
  ds_read_b64_tr_b16 v[156:157], v6 offset:30784
  ds_read_b64_tr_b16 v[158:159], v6 offset:31552
  ds_read_b64_tr_b16 v[160:161], v6 offset:30848
  ds_read_b64_tr_b16 v[162:163], v6 offset:31616
  v_mfma_f32_32x32x16_bf16 v[112:127], v[172:175], v[136:139], v[112:127]
  s_waitcnt lgkmcnt(7)
  v_mfma_f32_32x32x16_bf16 v[80:95], v[140:143], v[128:131], v[80:95]
  ds_read_b128 v[136:139], v5 offset:32768
  ds_read_b64_tr_b16 v[164:165], v6 offset:33792
  ds_read_b64_tr_b16 v[166:167], v6 offset:34560
  v_mfma_f32_32x32x16_bf16 v[96:111], v[144:147], v[128:131], v[96:111]
  ds_read_b64_tr_b16 v[168:169], v6 offset:33856
  ds_read_b64_tr_b16 v[170:171], v6 offset:34624
  ds_read_b64_tr_b16 v[172:173], v6 offset:33920
  ds_read_b64_tr_b16 v[174:175], v6 offset:34688
  v_mfma_f32_32x32x16_bf16 v[112:127], v[148:151], v[128:131], v[112:127]
  s_waitcnt lgkmcnt(7)
  v_mfma_f32_32x32x16_bf16 v[80:95], v[152:155], v[132:135], v[80:95]
  s_barrier
  ds_read_b128 v[128:131], v2 offset:49152
  ds_read_b64_tr_b16 v[140:141], v6 offset:0
  ds_read_b64_tr_b16 v[142:143], v6 offset:768
  v_mfma_f32_32x32x16_bf16 v[96:111], v[156:159], v[132:135], v[96:111]
  ds_read_b64_tr_b16 v[144:145], v6 offset:64
  ds_read_b64_tr_b16 v[146:147], v6 offset:832
  ds_read_b64_tr_b16 v[148:149], v6 offset:128
  ds_read_b64_tr_b16 v[150:151], v6 offset:896
  v_mfma_f32_32x32x16_bf16 v[112:127], v[160:163], v[132:135], v[112:127]
  s_waitcnt lgkmcnt(7)
  v_mfma_f32_32x32x16_bf16 v[80:95], v[164:167], v[136:139], v[80:95]
  ds_read_b128 v[132:135], v3 offset:49152
  ds_read_b64_tr_b16 v[152:153], v6 offset:3072
  ds_read_b64_tr_b16 v[154:155], v6 offset:3840
  v_mfma_f32_32x32x16_bf16 v[96:111], v[168:171], v[136:139], v[96:111]
  ds_read_b64_tr_b16 v[156:157], v6 offset:3136
  ds_read_b64_tr_b16 v[158:159], v6 offset:3904
  ds_read_b64_tr_b16 v[160:161], v6 offset:3200
  ds_read_b64_tr_b16 v[162:163], v6 offset:3968
  v_mfma_f32_32x32x16_bf16 v[112:127], v[172:175], v[136:139], v[112:127]
  s_waitcnt lgkmcnt(7)
  v_mfma_f32_32x32x16_bf16 v[80:95], v[140:143], v[128:131], v[80:95]
  s_barrier
  ds_read_b128 v[136:139], v4 offset:49152
  ds_read_b64_tr_b16 v[164:165], v6 offset:6144
  ds_read_b64_tr_b16 v[166:167], v6 offset:6912
  v_mfma_f32_32x32x16_bf16 v[96:111], v[144:147], v[128:131], v[96:111]
  ds_read_b64_tr_b16 v[168:169], v6 offset:6208
  ds_read_b64_tr_b16 v[170:171], v6 offset:6976
  ds_read_b64_tr_b16 v[172:173], v6 offset:6272
  ds_read_b64_tr_b16 v[174:175], v6 offset:7040
  v_mfma_f32_32x32x16_bf16 v[112:127], v[148:151], v[128:131], v[112:127]
  s_waitcnt lgkmcnt(7)
  v_mfma_f32_32x32x16_bf16 v[80:95], v[152:155], v[132:135], v[80:95]
  ds_read_b128 v[128:131], v5 offset:49152
  ds_read_b64_tr_b16 v[140:141], v6 offset:9216
  ds_read_b64_tr_b16 v[142:143], v6 offset:9984
  v_mfma_f32_32x32x16_bf16 v[96:111], v[156:159], v[132:135], v[96:111]
  ds_read_b64_tr_b16 v[144:145], v6 offset:9280
  ds_read_b64_tr_b16 v[146:147], v6 offset:10048
  ds_read_b64_tr_b16 v[148:149], v6 offset:9344
  ds_read_b64_tr_b16 v[150:151], v6 offset:10112
  v_mfma_f32_32x32x16_bf16 v[112:127], v[160:163], v[132:135], v[112:127]
  s_waitcnt lgkmcnt(7)
  v_mfma_f32_32x32x16_bf16 v[80:95], v[164:167], v[136:139], v[80:95]
  v_mfma_f32_32x32x16_bf16 v[96:111], v[168:171], v[136:139], v[96:111]
  v_mfma_f32_32x32x16_bf16 v[112:127], v[172:175], v[136:139], v[112:127]
  s_waitcnt lgkmcnt(0)
  v_mfma_f32_32x32x16_bf16 v[80:95], v[140:143], v[128:131], v[80:95]
  v_mfma_f32_32x32x16_bf16 v[96:111], v[144:147], v[128:131], v[96:111]
  v_mfma_f32_32x32x16_bf16 v[112:127], v[148:151], v[128:131], v[112:127]
  s_waitcnt lgkmcnt(0)
  s_barrier
  v_lshlrev_b32 v7, 4, v15
  v_add_u32 v7, 162688, v7
  ds_read_b128 v[32:35], v7 offset:0
  ds_read_b128 v[36:39], v7 offset:32
  ds_read_b128 v[40:43], v7 offset:64
  ds_read_b128 v[44:47], v7 offset:96
  ds_read_b128 v[48:51], v7 offset:128
  ds_read_b128 v[52:55], v7 offset:160
  ds_read_b128 v[56:59], v7 offset:192
  ds_read_b128 v[60:63], v7 offset:224
  ds_read_b128 v[64:67], v7 offset:256
  ds_read_b128 v[68:71], v7 offset:288
  ds_read_b128 v[72:75], v7 offset:320
  ds_read_b128 v[76:79], v7 offset:352
  ds_read_b128 v[176:179], v7 offset:512
  ds_read_b128 v[180:183], v7 offset:544
  ds_read_b128 v[184:187], v7 offset:576
  ds_read_b128 v[188:191], v7 offset:608
  ds_read_b128 v[192:195], v7 offset:640
  ds_read_b128 v[196:199], v7 offset:672
  ds_read_b128 v[200:203], v7 offset:704
  ds_read_b128 v[204:207], v7 offset:736
  ds_read_b128 v[208:211], v7 offset:768
  ds_read_b128 v[212:215], v7 offset:800
  ds_read_b128 v[216:219], v7 offset:832
  ds_read_b128 v[220:223], v7 offset:864
  v_mov_b32 v10, 0xc0135761
  v_mov_b32 v11, 0xc0135761
  v_mov_b32 v12, 0xbdd2d3e8
  v_mov_b32 v13, 0xbdd2d3e8
  s_mul_i32 s47, s59, 118
  s_add_u32 s47, s47, s53
  s_add_u32 s47, s47, 32
  s_lshl_b32 s47, s47, 10
  s_add_u32 s61, s47, 8388608
  s_waitcnt lgkmcnt(0)
  v_pk_fma_f32 v[232:233], v[32:33], v[18:19], v[176:177] op_sel:[0,1,0] op_sel_hi:[1,1,1] neg_lo:[1,0,0] neg_hi:[1,0,0]
  v_pk_fma_f32 v[234:235], v[34:35], v[18:19], v[178:179] op_sel:[0,1,0] op_sel_hi:[1,1,1] neg_lo:[1,0,0] neg_hi:[1,0,0]
  v_pk_fma_f32 v[236:237], v[36:37], v[18:19], v[180:181] op_sel:[0,1,0] op_sel_hi:[1,1,1] neg_lo:[1,0,0] neg_hi:[1,0,0]
  v_pk_fma_f32 v[238:239], v[38:39], v[18:19], v[182:183] op_sel:[0,1,0] op_sel_hi:[1,1,1] neg_lo:[1,0,0] neg_hi:[1,0,0]
  v_pk_fma_f32 v[80:81], v[80:81], v[18:19], v[232:233] op_sel_hi:[1,0,1]
  v_pk_fma_f32 v[82:83], v[82:83], v[18:19], v[234:235] op_sel_hi:[1,0,1]
  v_pk_fma_f32 v[84:85], v[84:85], v[18:19], v[236:237] op_sel_hi:[1,0,1]
  v_pk_fma_f32 v[86:87], v[86:87], v[18:19], v[238:239] op_sel_hi:[1,0,1]
  v_pk_mul_f32 v[232:233], v[80:81], v[80:81]
  v_pk_mul_f32 v[234:235], v[82:83], v[82:83]
  v_pk_mul_f32 v[236:237], v[84:85], v[84:85]
  v_pk_mul_f32 v[238:239], v[86:87], v[86:87]
  v_pk_fma_f32 v[232:233], v[232:233], v[12:13], v[10:11]
  v_pk_fma_f32 v[234:235], v[234:235], v[12:13], v[10:11]
  v_pk_fma_f32 v[236:237], v[236:237], v[12:13], v[10:11]
  v_pk_fma_f32 v[238:239], v[238:239], v[12:13], v[10:11]
  v_pk_mul_f32 v[232:233], v[80:81], v[232:233]
  v_pk_mul_f32 v[234:235], v[82:83], v[234:235]
  v_pk_mul_f32 v[236:237], v[84:85], v[236:237]
  v_pk_mul_f32 v[238:239], v[86:87], v[238:239]
  v_exp_f32 v232, v232
  v_exp_f32 v233, v233
  v_exp_f32 v234, v234
  v_exp_f32 v235, v235
  v_exp_f32 v236, v236
  v_exp_f32 v237, v237
  v_exp_f32 v238, v238
  v_exp_f32 v239, v239
  v_pk_add_f32 v[232:233], v[232:233], 1.0 op_sel_hi:[1,0]
  v_pk_add_f32 v[234:235], v[234:235], 1.0 op_sel_hi:[1,0]
  v_pk_add_f32 v[236:237], v[236:237], 1.0 op_sel_hi:[1,0]
  v_pk_add_f32 v[238:239], v[238:239], 1.0 op_sel_hi:[1,0]
  v_rcp_f32 v232, v232
  v_rcp_f32 v233, v233
  v_rcp_f32 v234, v234
  v_rcp_f32 v235, v235
  v_rcp_f32 v236, v236
  v_rcp_f32 v237, v237
  v_rcp_f32 v238, v238
  v_rcp_f32 v239, v239
  v_pk_mul_f32 v[80:81], v[80:81], v[232:233]
  v_pk_mul_f32 v[82:83], v[82:83], v[234:235]
  v_pk_mul_f32 v[84:85], v[84:85], v[236:237]
  v_pk_mul_f32 v[86:87], v[86:87], v[238:239]
  v_cvt_pk_bf16_f32 v224, v80, v81
  v_cvt_pk_bf16_f32 v225, v82, v83
  v_cvt_pk_bf16_f32 v226, v84, v85
  v_cvt_pk_bf16_f32 v227, v86, v87
  s_add_u32 s62, s61, 0
  buffer_store_dwordx4 v[224:227], v8, s[32:35], s62 offen sc1
  v_pk_fma_f32 v[232:233], v[40:41], v[18:19], v[184:185] op_sel:[0,1,0] op_sel_hi:[1,1,1] neg_lo:[1,0,0] neg_hi:[1,0,0]
  v_pk_fma_f32 v[234:235], v[42:43], v[18:19], v[186:187] op_sel:[0,1,0] op_sel_hi:[1,1,1] neg_lo:[1,0,0] neg_hi:[1,0,0]
  v_pk_fma_f32 v[236:237], v[44:45], v[18:19], v[188:189] op_sel:[0,1,0] op_sel_hi:[1,1,1] neg_lo:[1,0,0] neg_hi:[1,0,0]
  v_pk_fma_f32 v[238:239], v[46:47], v[18:19], v[190:191] op_sel:[0,1,0] op_sel_hi:[1,1,1] neg_lo:[1,0,0] neg_hi:[1,0,0]
  v_pk_fma_f32 v[88:89], v[88:89], v[18:19], v[232:233] op_sel_hi:[1,0,1]
  v_pk_fma_f32 v[90:91], v[90:91], v[18:19], v[234:235] op_sel_hi:[1,0,1]
  v_pk_fma_f32 v[92:93], v[92:93], v[18:19], v[236:237] op_sel_hi:[1,0,1]
  v_pk_fma_f32 v[94:95], v[94:95], v[18:19], v[238:239] op_sel_hi:[1,0,1]
  v_pk_mul_f32 v[232:233], v[88:89], v[88:89]
  v_pk_mul_f32 v[234:235], v[90:91], v[90:91]
  v_pk_mul_f32 v[236:237], v[92:93], v[92:93]
  v_pk_mul_f32 v[238:239], v[94:95], v[94:95]
  v_pk_fma_f32 v[232:233], v[232:233], v[12:13], v[10:11]
  v_pk_fma_f32 v[234:235], v[234:235], v[12:13], v[10:11]
  v_pk_fma_f32 v[236:237], v[236:237], v[12:13], v[10:11]
  v_pk_fma_f32 v[238:239], v[238:239], v[12:13], v[10:11]
  v_pk_mul_f32 v[232:233], v[88:89], v[232:233]
  v_pk_mul_f32 v[234:235], v[90:91], v[234:235]
  v_pk_mul_f32 v[236:237], v[92:93], v[236:237]
  v_pk_mul_f32 v[238:239], v[94:95], v[238:239]
  v_exp_f32 v232, v232
  v_exp_f32 v233, v233
  v_exp_f32 v234, v234
  v_exp_f32 v235, v235
  v_exp_f32 v236, v236
  v_exp_f32 v237, v237
  v_exp_f32 v238, v238
  v_exp_f32 v239, v239
  v_pk_add_f32 v[232:233], v[232:233], 1.0 op_sel_hi:[1,0]
  v_pk_add_f32 v[234:235], v[234:235], 1.0 op_sel_hi:[1,0]
  v_pk_add_f32 v[236:237], v[236:237], 1.0 op_sel_hi:[1,0]
  v_pk_add_f32 v[238:239], v[238:239], 1.0 op_sel_hi:[1,0]
  v_rcp_f32 v232, v232
  v_rcp_f32 v233, v233
  v_rcp_f32 v234, v234
  v_rcp_f32 v235, v235
  v_rcp_f32 v236, v236
  v_rcp_f32 v237, v237
  v_rcp_f32 v238, v238
  v_rcp_f32 v239, v239
  v_pk_mul_f32 v[88:89], v[88:89], v[232:233]
  v_pk_mul_f32 v[90:91], v[90:91], v[234:235]
  v_pk_mul_f32 v[92:93], v[92:93], v[236:237]
  v_pk_mul_f32 v[94:95], v[94:95], v[238:239]
  v_cvt_pk_bf16_f32 v228, v88, v89
  v_cvt_pk_bf16_f32 v229, v90, v91
  v_cvt_pk_bf16_f32 v230, v92, v93
  v_cvt_pk_bf16_f32 v231, v94, v95
  s_add_u32 s62, s61, 1024
  buffer_store_dwordx4 v[228:231], v8, s[32:35], s62 offen sc1
  v_pk_fma_f32 v[232:233], v[48:49], v[18:19], v[192:193] op_sel:[0,1,0] op_sel_hi:[1,1,1] neg_lo:[1,0,0] neg_hi:[1,0,0]
  v_pk_fma_f32 v[234:235], v[50:51], v[18:19], v[194:195] op_sel:[0,1,0] op_sel_hi:[1,1,1] neg_lo:[1,0,0] neg_hi:[1,0,0]
  v_pk_fma_f32 v[236:237], v[52:53], v[18:19], v[196:197] op_sel:[0,1,0] op_sel_hi:[1,1,1] neg_lo:[1,0,0] neg_hi:[1,0,0]
  v_pk_fma_f32 v[238:239], v[54:55], v[18:19], v[198:199] op_sel:[0,1,0] op_sel_hi:[1,1,1] neg_lo:[1,0,0] neg_hi:[1,0,0]
  v_pk_fma_f32 v[96:97], v[96:97], v[18:19], v[232:233] op_sel_hi:[1,0,1]
  v_pk_fma_f32 v[98:99], v[98:99], v[18:19], v[234:235] op_sel_hi:[1,0,1]
  v_pk_fma_f32 v[100:101], v[100:101], v[18:19], v[236:237] op_sel_hi:[1,0,1]
  v_pk_fma_f32 v[102:103], v[102:103], v[18:19], v[238:239] op_sel_hi:[1,0,1]
  v_pk_mul_f32 v[232:233], v[96:97], v[96:97]
  v_pk_mul_f32 v[234:235], v[98:99], v[98:99]
  v_pk_mul_f32 v[236:237], v[100:101], v[100:101]
  v_pk_mul_f32 v[238:239], v[102:103], v[102:103]
  v_pk_fma_f32 v[232:233], v[232:233], v[12:13], v[10:11]
  v_pk_fma_f32 v[234:235], v[234:235], v[12:13], v[10:11]
  v_pk_fma_f32 v[236:237], v[236:237], v[12:13], v[10:11]
  v_pk_fma_f32 v[238:239], v[238:239], v[12:13], v[10:11]
  v_pk_mul_f32 v[232:233], v[96:97], v[232:233]
  v_pk_mul_f32 v[234:235], v[98:99], v[234:235]
  v_pk_mul_f32 v[236:237], v[100:101], v[236:237]
  v_pk_mul_f32 v[238:239], v[102:103], v[238:239]
  v_exp_f32 v232, v232
  v_exp_f32 v233, v233
  v_exp_f32 v234, v234
  v_exp_f32 v235, v235
  v_exp_f32 v236, v236
  v_exp_f32 v237, v237
  v_exp_f32 v238, v238
  v_exp_f32 v239, v239
  v_pk_add_f32 v[232:233], v[232:233], 1.0 op_sel_hi:[1,0]
  v_pk_add_f32 v[234:235], v[234:235], 1.0 op_sel_hi:[1,0]
  v_pk_add_f32 v[236:237], v[236:237], 1.0 op_sel_hi:[1,0]
  v_pk_add_f32 v[238:239], v[238:239], 1.0 op_sel_hi:[1,0]
  v_rcp_f32 v232, v232
  v_rcp_f32 v233, v233
  v_rcp_f32 v234, v234
  v_rcp_f32 v235, v235
  v_rcp_f32 v236, v236
  v_rcp_f32 v237, v237
  v_rcp_f32 v238, v238
  v_rcp_f32 v239, v239
  v_pk_mul_f32 v[96:97], v[96:97], v[232:233]
  v_pk_mul_f32 v[98:99], v[98:99], v[234:235]
  v_pk_mul_f32 v[100:101], v[100:101], v[236:237]
  v_pk_mul_f32 v[102:103], v[102:103], v[238:239]
  v_cvt_pk_bf16_f32 v224, v96, v97
  v_cvt_pk_bf16_f32 v225, v98, v99
  v_cvt_pk_bf16_f32 v226, v100, v101
  v_cvt_pk_bf16_f32 v227, v102, v103
  s_add_u32 s62, s61, 2048
  buffer_store_dwordx4 v[224:227], v8, s[32:35], s62 offen sc1
  v_pk_fma_f32 v[232:233], v[56:57], v[18:19], v[200:201] op_sel:[0,1,0] op_sel_hi:[1,1,1] neg_lo:[1,0,0] neg_hi:[1,0,0]
  v_pk_fma_f32 v[234:235], v[58:59], v[18:19], v[202:203] op_sel:[0,1,0] op_sel_hi:[1,1,1] neg_lo:[1,0,0] neg_hi:[1,0,0]
  v_pk_fma_f32 v[236:237], v[60:61], v[18:19], v[204:205] op_sel:[0,1,0] op_sel_hi:[1,1,1] neg_lo:[1,0,0] neg_hi:[1,0,0]
  v_pk_fma_f32 v[238:239], v[62:63], v[18:19], v[206:207] op_sel:[0,1,0] op_sel_hi:[1,1,1] neg_lo:[1,0,0] neg_hi:[1,0,0]
  v_pk_fma_f32 v[104:105], v[104:105], v[18:19], v[232:233] op_sel_hi:[1,0,1]
  v_pk_fma_f32 v[106:107], v[106:107], v[18:19], v[234:235] op_sel_hi:[1,0,1]
  v_pk_fma_f32 v[108:109], v[108:109], v[18:19], v[236:237] op_sel_hi:[1,0,1]
  v_pk_fma_f32 v[110:111], v[110:111], v[18:19], v[238:239] op_sel_hi:[1,0,1]
  v_pk_mul_f32 v[232:233], v[104:105], v[104:105]
  v_pk_mul_f32 v[234:235], v[106:107], v[106:107]
  v_pk_mul_f32 v[236:237], v[108:109], v[108:109]
  v_pk_mul_f32 v[238:239], v[110:111], v[110:111]
  v_pk_fma_f32 v[232:233], v[232:233], v[12:13], v[10:11]
  v_pk_fma_f32 v[234:235], v[234:235], v[12:13], v[10:11]
  v_pk_fma_f32 v[236:237], v[236:237], v[12:13], v[10:11]
  v_pk_fma_f32 v[238:239], v[238:239], v[12:13], v[10:11]
  v_pk_mul_f32 v[232:233], v[104:105], v[232:233]
  v_pk_mul_f32 v[234:235], v[106:107], v[234:235]
  v_pk_mul_f32 v[236:237], v[108:109], v[236:237]
  v_pk_mul_f32 v[238:239], v[110:111], v[238:239]
  v_exp_f32 v232, v232
  v_exp_f32 v233, v233
  v_exp_f32 v234, v234
  v_exp_f32 v235, v235
  v_exp_f32 v236, v236
  v_exp_f32 v237, v237
  v_exp_f32 v238, v238
  v_exp_f32 v239, v239
  v_pk_add_f32 v[232:233], v[232:233], 1.0 op_sel_hi:[1,0]
  v_pk_add_f32 v[234:235], v[234:235], 1.0 op_sel_hi:[1,0]
  v_pk_add_f32 v[236:237], v[236:237], 1.0 op_sel_hi:[1,0]
  v_pk_add_f32 v[238:239], v[238:239], 1.0 op_sel_hi:[1,0]
  v_rcp_f32 v232, v232
  v_rcp_f32 v233, v233
  v_rcp_f32 v234, v234
  v_rcp_f32 v235, v235
  v_rcp_f32 v236, v236
  v_rcp_f32 v237, v237
  v_rcp_f32 v238, v238
  v_rcp_f32 v239, v239
  v_pk_mul_f32 v[104:105], v[104:105], v[232:233]
  v_pk_mul_f32 v[106:107], v[106:107], v[234:235]
  v_pk_mul_f32 v[108:109], v[108:109], v[236:237]
  v_pk_mul_f32 v[110:111], v[110:111], v[238:239]
  v_cvt_pk_bf16_f32 v228, v104, v105
  v_cvt_pk_bf16_f32 v229, v106, v107
  v_cvt_pk_bf16_f32 v230, v108, v109
  v_cvt_pk_bf16_f32 v231, v110, v111
  s_add_u32 s62, s61, 3072
  buffer_store_dwordx4 v[228:231], v8, s[32:35], s62 offen sc1
  v_pk_fma_f32 v[232:233], v[64:65], v[18:19], v[208:209] op_sel:[0,1,0] op_sel_hi:[1,1,1] neg_lo:[1,0,0] neg_hi:[1,0,0]
  v_pk_fma_f32 v[234:235], v[66:67], v[18:19], v[210:211] op_sel:[0,1,0] op_sel_hi:[1,1,1] neg_lo:[1,0,0] neg_hi:[1,0,0]
  v_pk_fma_f32 v[236:237], v[68:69], v[18:19], v[212:213] op_sel:[0,1,0] op_sel_hi:[1,1,1] neg_lo:[1,0,0] neg_hi:[1,0,0]
  v_pk_fma_f32 v[238:239], v[70:71], v[18:19], v[214:215] op_sel:[0,1,0] op_sel_hi:[1,1,1] neg_lo:[1,0,0] neg_hi:[1,0,0]
  v_pk_fma_f32 v[112:113], v[112:113], v[18:19], v[232:233] op_sel_hi:[1,0,1]
  v_pk_fma_f32 v[114:115], v[114:115], v[18:19], v[234:235] op_sel_hi:[1,0,1]
  v_pk_fma_f32 v[116:117], v[116:117], v[18:19], v[236:237] op_sel_hi:[1,0,1]
  v_pk_fma_f32 v[118:119], v[118:119], v[18:19], v[238:239] op_sel_hi:[1,0,1]
  v_pk_mul_f32 v[232:233], v[112:113], v[112:113]
  v_pk_mul_f32 v[234:235], v[114:115], v[114:115]
  v_pk_mul_f32 v[236:237], v[116:117], v[116:117]
  v_pk_mul_f32 v[238:239], v[118:119], v[118:119]
  v_pk_fma_f32 v[232:233], v[232:233], v[12:13], v[10:11]
  v_pk_fma_f32 v[234:235], v[234:235], v[12:13], v[10:11]
  v_pk_fma_f32 v[236:237], v[236:237], v[12:13], v[10:11]
  v_pk_fma_f32 v[238:239], v[238:239], v[12:13], v[10:11]
  v_pk_mul_f32 v[232:233], v[112:113], v[232:233]
  v_pk_mul_f32 v[234:235], v[114:115], v[234:235]
  v_pk_mul_f32 v[236:237], v[116:117], v[236:237]
  v_pk_mul_f32 v[238:239], v[118:119], v[238:239]
  v_exp_f32 v232, v232
  v_exp_f32 v233, v233
  v_exp_f32 v234, v234
  v_exp_f32 v235, v235
  v_exp_f32 v236, v236
  v_exp_f32 v237, v237
  v_exp_f32 v238, v238
  v_exp_f32 v239, v239
  v_pk_add_f32 v[232:233], v[232:233], 1.0 op_sel_hi:[1,0]
  v_pk_add_f32 v[234:235], v[234:235], 1.0 op_sel_hi:[1,0]
  v_pk_add_f32 v[236:237], v[236:237], 1.0 op_sel_hi:[1,0]
  v_pk_add_f32 v[238:239], v[238:239], 1.0 op_sel_hi:[1,0]
  v_rcp_f32 v232, v232
  v_rcp_f32 v233, v233
  v_rcp_f32 v234, v234
  v_rcp_f32 v235, v235
  v_rcp_f32 v236, v236
  v_rcp_f32 v237, v237
  v_rcp_f32 v238, v238
  v_rcp_f32 v239, v239
  v_pk_mul_f32 v[112:113], v[112:113], v[232:233]
  v_pk_mul_f32 v[114:115], v[114:115], v[234:235]
  v_pk_mul_f32 v[116:117], v[116:117], v[236:237]
  v_pk_mul_f32 v[118:119], v[118:119], v[238:239]
  v_cvt_pk_bf16_f32 v224, v112, v113
  v_cvt_pk_bf16_f32 v225, v114, v115
  v_cvt_pk_bf16_f32 v226, v116, v117
  v_cvt_pk_bf16_f32 v227, v118, v119
  s_add_u32 s62, s61, 4096
  buffer_store_dwordx4 v[224:227], v8, s[32:35], s62 offen sc1
  s_cmp_lt_u32 s70, 6
  s_cbranch_scc1 L_hskip_1
  v_pk_fma_f32 v[232:233], v[72:73], v[18:19], v[216:217] op_sel:[0,1,0] op_sel_hi:[1,1,1] neg_lo:[1,0,0] neg_hi:[1,0,0]
  v_pk_fma_f32 v[234:235], v[74:75], v[18:19], v[218:219] op_sel:[0,1,0] op_sel_hi:[1,1,1] neg_lo:[1,0,0] neg_hi:[1,0,0]
  v_pk_fma_f32 v[236:237], v[76:77], v[18:19], v[220:221] op_sel:[0,1,0] op_sel_hi:[1,1,1] neg_lo:[1,0,0] neg_hi:[1,0,0]
  v_pk_fma_f32 v[238:239], v[78:79], v[18:19], v[222:223] op_sel:[0,1,0] op_sel_hi:[1,1,1] neg_lo:[1,0,0] neg_hi:[1,0,0]
  v_pk_fma_f32 v[120:121], v[120:121], v[18:19], v[232:233] op_sel_hi:[1,0,1]
  v_pk_fma_f32 v[122:123], v[122:123], v[18:19], v[234:235] op_sel_hi:[1,0,1]
  v_pk_fma_f32 v[124:125], v[124:125], v[18:19], v[236:237] op_sel_hi:[1,0,1]
  v_pk_fma_f32 v[126:127], v[126:127], v[18:19], v[238:239] op_sel_hi:[1,0,1]
  v_pk_mul_f32 v[232:233], v[120:121], v[120:121]
  v_pk_mul_f32 v[234:235], v[122:123], v[122:123]
  v_pk_mul_f32 v[236:237], v[124:125], v[124:125]
  v_pk_mul_f32 v[238:239], v[126:127], v[126:127]
  v_pk_fma_f32 v[232:233], v[232:233], v[12:13], v[10:11]
  v_pk_fma_f32 v[234:235], v[234:235], v[12:13], v[10:11]
  v_pk_fma_f32 v[236:237], v[236:237], v[12:13], v[10:11]
  v_pk_fma_f32 v[238:239], v[238:239], v[12:13], v[10:11]
  v_pk_mul_f32 v[232:233], v[120:121], v[232:233]
  v_pk_mul_f32 v[234:235], v[122:123], v[234:235]
  v_pk_mul_f32 v[236:237], v[124:125], v[236:237]
  v_pk_mul_f32 v[238:239], v[126:127], v[238:239]
  v_exp_f32 v232, v232
  v_exp_f32 v233, v233
  v_exp_f32 v234, v234
  v_exp_f32 v235, v235
  v_exp_f32 v236, v236
  v_exp_f32 v237, v237
  v_exp_f32 v238, v238
  v_exp_f32 v239, v239
  v_pk_add_f32 v[232:233], v[232:233], 1.0 op_sel_hi:[1,0]
  v_pk_add_f32 v[234:235], v[234:235], 1.0 op_sel_hi:[1,0]
  v_pk_add_f32 v[236:237], v[236:237], 1.0 op_sel_hi:[1,0]
  v_pk_add_f32 v[238:239], v[238:239], 1.0 op_sel_hi:[1,0]
  v_rcp_f32 v232, v232
  v_rcp_f32 v233, v233
  v_rcp_f32 v234, v234
  v_rcp_f32 v235, v235
  v_rcp_f32 v236, v236
  v_rcp_f32 v237, v237
  v_rcp_f32 v238, v238
  v_rcp_f32 v239, v239
  v_pk_mul_f32 v[120:121], v[120:121], v[232:233]
  v_pk_mul_f32 v[122:123], v[122:123], v[234:235]
  v_pk_mul_f32 v[124:125], v[124:125], v[236:237]
  v_pk_mul_f32 v[126:127], v[126:127], v[238:239]
  v_cvt_pk_bf16_f32 v228, v120, v121
  v_cvt_pk_bf16_f32 v229, v122, v123
  v_cvt_pk_bf16_f32 v230, v124, v125
  v_cvt_pk_bf16_f32 v231, v126, v127
  s_add_u32 s62, s61, 5120
  buffer_store_dwordx4 v[228:231], v8, s[32:35], s62 offen sc1
L_hskip_1:
  s_nop 1
  s_and_b32 s46, s2, 7
  s_lshr_b32 s47, s2, 3
  s_and_b32 s56, s47, 3
  s_lshl_b32 s48, s46, 2
  s_add_u32 s56, s56, s48
  s_lshr_b32 s57, s47, 2
  s_and_b32 s54, s26, 3
  s_lshr_b32 s55, s26, 2
  s_lshl_b32 s58, s57, 3
  s_lshl_b32 s48, s54, 1
  s_add_u32 s58, s58, s48
  s_lshl_b32 s44, s46, 3
  s_and_b32 s48, s47, 7
  s_add_u32 s44, s44, s48
  s_lshr_b32 s45, s47, 3
  s_lshl_b32 s52, s45, 2
  s_add_u32 s52, s52, s54
  s_mul_i32 s48, s55, 43
  s_add_u32 s48, s48, 32
  s_mul_i32 s49, s52, 118
  s_add_u32 s49, s49, s48
  s_lshl_b32 s49, s49, 10
  s_add_u32 s49, s49, 65536
  s_add_u32 s36, s24, s49
  s_addc_u32 s37, s25, 0
  s_and_b32 s37, s37, 0xffff
  s_mov_b32 s38, 44032
  s_mov_b32 s39, 0x20000
  s_mul_i32 s49, s44, 118
  s_add_u32 s49, s49, s48
  s_lshl_b32 s49, s49, 10
  s_add_u32 s49, s49, 8388608
  s_add_u32 s40, s24, s49
  s_addc_u32 s41, s25, 0
  s_and_b32 s41, s41, 0xffff
  s_mov_b32 s42, 44032
  s_mov_b32 s43, 0x20000
  v_lshlrev_b32 v2, 4, v1
  v_lshrrev_b32 v8, 5, v1
  v_bfe_u32 v9, v1, 2, 2
  v_lshl_add_u32 v9, v8, 2, v9
  v_lshlrev_b32 v9, 5, v9
  v_and_b32 v10, 3, v1
  v_lshl_add_u32 v9, v10, 3, v9
  v_add_u32 v9, 65536, v9
  v_xor_b32 v10, 1, v8
  v_lshlrev_b32 v10, 7, v10
  v_and_b32 v11, 15, v1
  v_lshl_add_u32 v10, v11, 3, v10
  v_add_u32 v10, 131072, v10
  v_bfe_u32 v11, v1, 4, 1
  v_cmp_eq_u32 s[70:71], 1, v11
  v_mov_b32 v15, 2048
  v_mov_b32 v16, 0
  v_cndmask_b32 v14, v9, v10, s[70:71]
  v_cndmask_b32 v7, v15, v16, s[70:71]
  v_mov_b32 v168, 0
  v_mov_b32 v169, 0
  v_mov_b32 v170, 0
  v_mov_b32 v171, 0
  v_mov_b32 v172, 0
  v_mov_b32 v173, 0
  v_mov_b32 v174, 0
  v_mov_b32 v175, 0
  v_mov_b32 v176, 0
  v_mov_b32 v177, 0
  v_mov_b32 v178, 0
  v_mov_b32 v179, 0
  v_mov_b32 v180, 0
  v_mov_b32 v181, 0
  v_mov_b32 v182, 0
  v_mov_b32 v183, 0
  v_mov_b32 v184, 0
  v_mov_b32 v185, 0
  v_mov_b32 v186, 0
  v_mov_b32 v187, 0
  v_mov_b32 v188, 0
  v_mov_b32 v189, 0
  v_mov_b32 v190, 0
  v_mov_b32 v191, 0
  v_mov_b32 v192, 0
  v_mov_b32 v193, 0
  v_mov_b32 v194, 0
  v_mov_b32 v195, 0
  v_mov_b32 v196, 0
  v_mov_b32 v197, 0
  v_mov_b32 v198, 0
  v_mov_b32 v199, 0
  v_mov_b32 v200, 0
  v_mov_b32 v201, 0
  v_mov_b32 v202, 0
  v_mov_b32 v203, 0
  v_mov_b32 v204, 0
  v_mov_b32 v205, 0
  v_mov_b32 v206, 0
  v_mov_b32 v207, 0
  v_mov_b32 v208, 0
  v_mov_b32 v209, 0
  v_mov_b32 v210, 0
  v_mov_b32 v211, 0
  v_mov_b32 v212, 0
  v_mov_b32 v213, 0
  v_mov_b32 v214, 0
  v_mov_b32 v215, 0
  s_mov_b32 s50, 0
  s_lshl_b32 s51, s55, 5
  s_mov_b32 s53, 4
  s_mov_b32 s59, 0
  v_mov_b32 v96, 0
  v_mov_b32 v112, 0
  v_mov_b32 v97, 0
  v_mov_b32 v113, 0
  v_mov_b32 v98, 0
  v_mov_b32 v114, 0
  v_mov_b32 v99, 0
  v_mov_b32 v115, 0
  v_mov_b32 v100, 0
  v_mov_b32 v116, 0
  v_mov_b32 v101, 0
  v_mov_b32 v117, 0
  v_mov_b32 v102, 0
  v_mov_b32 v118, 0
  v_mov_b32 v103, 0
  v_mov_b32 v119, 0
  v_mov_b32 v104, 0
  v_mov_b32 v120, 0
  v_mov_b32 v105, 0
  v_mov_b32 v121, 0
  v_mov_b32 v106, 0
  v_mov_b32 v122, 0
  v_mov_b32 v107, 0
  v_mov_b32 v123, 0
  v_mov_b32 v108, 0
  v_mov_b32 v124, 0
  v_mov_b32 v109, 0
  v_mov_b32 v125, 0
  v_mov_b32 v110, 0
  v_mov_b32 v126, 0
  v_mov_b32 v111, 0
  v_mov_b32 v127, 0
  v_mov_b32 v128, 0
  v_mov_b32 v160, 0
  v_mov_b32 v129, 0
  v_mov_b32 v161, 0
  v_mov_b32 v130, 0
  v_mov_b32 v162, 0
  v_mov_b32 v131, 0
  v_mov_b32 v163, 0
  v_mov_b32 v132, 0
  v_mov_b32 v164, 0
  v_mov_b32 v133, 0
  v_mov_b32 v165, 0
  v_mov_b32 v134, 0
  v_mov_b32 v166, 0
  v_mov_b32 v135, 0
  v_mov_b32 v167, 0
  s_setprio 0
  s_barrier
  s_branch L_attn
L_producer:
  s_cmp_ge_u32 s26, 6
  s_cbranch_scc1 L_jobwave
  s_sub_u32 s54, s26, 4
  s_lshl_b32 s47, s44, 7
  s_lshl_b32 s46, s54, 6
  s_add_u32 s47, s47, s46
  s_lshl_b32 s47, s47, 10
  s_mul_i32 s57, s45, 192
  s_mul_i32 s46, s54, 16*3072
  s_add_u32 s57, s57, s46
  s_lshl_b32 s58, s53, 5
  s_mul_i32 s46, s54, 16*2752
  s_add_u32 s58, s58, s46
  s_lshl_b32 s50, s54, 13
  s_mul_i32 s51, s54, 3072
  s_add_u32 s51, s51, 98304
  s_mov_b32 s36, s6
  s_and_b32 s37, s7, 0xffff
  s_mov_b32 s38, 0x180000
  s_mov_b32 s39, 0x20000
  s_add_u32 s46, s69, 0
  s_and_b32 s46, s46, 7
  s_lshl_b32 s46, s46, 6
  s_mul_i32 s46, s46, 3072
  s_add_u32 m0, s51, 0
  s_add_u32 s48, s46, s57
  buffer_load_dwordx4 v16, s[36:39], s48 offen offset:0 lds
  buffer_load_dwordx4 v17, s[36:39], s48 offen offset:1024 lds
  buffer_load_dwordx4 v18, s[36:39], s48 offen offset:2048 lds
  s_add_u32 s46, s69, 0
  s_and_b32 s46, s46, 7
  s_lshl_b32 s46, s46, 7
  s_add_u32 s46, s46, s47
  s_add_u32 m0, s50, 0
  s_mov_b32 s48, s46
  buffer_load_dwordx4 v2, s[28:31], s48 offen offset:0 lds
  s_add_u32 s48, s46, 7168
  buffer_load_dwordx4 v3, s[28:31], s48 offen offset:1024 lds
  s_add_u32 s48, s46, 14336
  buffer_load_dwordx4 v2, s[28:31], s48 offen offset:2048 lds
  s_add_u32 s48, s46, 21504
  buffer_load_dwordx4 v3, s[28:31], s48 offen offset:3072 lds
  s_add_u32 s46, s69, 0
  s_and_b32 s46, s46, 7
  s_lshl_b32 s46, s46, 7
  s_add_u32 s46, s46, s47
  s_add_u32 m0, s50, 4096
  s_add_u32 s48, s46, 32768
  buffer_load_dwordx4 v2, s[28:31], s48 offen offset:0 lds
  s_add_u32 s48, s46, 39936
  buffer_load_dwordx4 v3, s[28:31], s48 offen offset:1024 lds
  s_add_u32 s48, s46, 47104
  buffer_load_dwordx4 v2, s[28:31], s48 offen offset:2048 lds
  s_add_u32 s48, s46, 54272
  buffer_load_dwordx4 v3, s[28:31], s48 offen offset:3072 lds
  s_mov_b32 s40, s12
  s_and_b32 s41, s13, 0xffff
  s_mov_b32 s42, 0x158000
  s_mov_b32 s43, 0x20000
  s_add_u32 s46, s69, 0
  s_and_b32 s46, s46, 7
  s_lshl_b32 s46, s46, 6
  s_add_u32 s46, s46, 32
  s_mul_i32 s46, s46, 3072
  s_add_u32 m0, s51, 6144
  s_add_u32 s48, s46, s57
  buffer_load_dwordx4 v16, s[36:39], s48 offen offset:0 lds
  buffer_load_dwordx4 v17, s[36:39], s48 offen offset:1024 lds
  buffer_load_dwordx4 v18, s[36:39], s48 offen offset:2048 lds
  s_add_u32 s46, s69, 1
  s_and_b32 s46, s46, 7
  s_lshl_b32 s46, s46, 6
  s_mul_i32 s46, s46, 3072
  s_add_u32 m0, s51, 12288
  s_add_u32 s48, s46, s57
  buffer_load_dwordx4 v16, s[36:39], s48 offen offset:0 lds
  buffer_load_dwordx4 v17, s[36:39], s48 offen offset:1024 lds
  buffer_load_dwordx4 v18, s[36:39], s48 offen offset:2048 lds
  s_waitcnt vmcnt(6)
  s_barrier
  s_add_u32 s46, s69, 1
  s_and_b32 s46, s46, 7
  s_lshl_b32 s46, s46, 7
  s_add_u32 s46, s46, s47
  s_add_u32 m0, s50, 16384
  s_mov_b32 s48, s46
  buffer_load_dwordx4 v2, s[28:31], s48 offen offset:0 lds
  s_add_u32 s48, s46, 7168
  buffer_load_dwordx4 v3, s[28:31], s48 offen offset:1024 lds
  s_add_u32 s48, s46, 14336
  buffer_load_dwordx4 v2, s[28:31], s48 offen offset:2048 lds
  s_add_u32 s48, s46, 21504
  buffer_load_dwordx4 v3, s[28:31], s48 offen offset:3072 lds
  s_add_u32 s46, s69, 1
  s_and_b32 s46, s46, 7
  s_lshl_b32 s46, s46, 7
  s_add_u32 s46, s46, s47
  s_add_u32 m0, s50, 20480
  s_add_u32 s48, s46, 32768
  buffer_load_dwordx4 v2, s[28:31], s48 offen offset:0 lds
  s_add_u32 s48, s46, 39936
  buffer_load_dwordx4 v3, s[28:31], s48 offen offset:1024 lds
  s_add_u32 s48, s46, 47104
  buffer_load_dwordx4 v2, s[28:31], s48 offen offset:2048 lds
  s_add_u32 s48, s46, 54272
  buffer_load_dwordx4 v3, s[28:31], s48 offen offset:3072 lds
  s_add_u32 s46, s69, 1
  s_and_b32 s46, s46, 7
  s_lshl_b32 s46, s46, 6
  s_add_u32 s46, s46, 32
  s_mul_i32 s46, s46, 3072
  s_add_u32 m0, s51, 18432
  s_add_u32 s48, s46, s57
  buffer_load_dwordx4 v16, s[36:39], s48 offen offset:0 lds
  buffer_load_dwordx4 v17, s[36:39], s48 offen offset:1024 lds
  buffer_load_dwordx4 v18, s[36:39], s48 offen offset:2048 lds
  s_add_u32 s46, s69, 2
  s_and_b32 s46, s46, 7
  s_lshl_b32 s46, s46, 7
  s_add_u32 s46, s46, s47
  s_add_u32 m0, s50, 32768
  s_mov_b32 s48, s46
  buffer_load_dwordx4 v2, s[28:31], s48 offen offset:0 lds
  s_add_u32 s48, s46, 7168
  buffer_load_dwordx4 v3, s[28:31], s48 offen offset:1024 lds
  s_add_u32 s48, s46, 14336
  buffer_load_dwordx4 v2, s[28:31], s48 offen offset:2048 lds
  s_add_u32 s48, s46, 21504
  buffer_load_dwordx4 v3, s[28:31], s48 offen offset:3072 lds
  s_add_u32 s46, s69, 2
  s_and_b32 s46, s46, 7
  s_lshl_b32 s46, s46, 7
  s_add_u32 s46, s46, s47
  s_add_u32 m0, s50, 36864
  s_add_u32 s48, s46, 32768
  buffer_load_dwordx4 v2, s[28:31], s48 offen offset:0 lds
  s_add_u32 s48, s46, 39936
  buffer_load_dwordx4 v3, s[28:31], s48 offen offset:1024 lds
  s_add_u32 s48, s46, 47104
  buffer_load_dwordx4 v2, s[28:31], s48 offen offset:2048 lds
  s_add_u32 s48, s46, 54272
  buffer_load_dwordx4 v3, s[28:31], s48 offen offset:3072 lds
  s_waitcnt vmcnt(22)
  s_barrier
  s_add_u32 s46, s69, 2
  s_and_b32 s46, s46, 7
  s_lshl_b32 s46, s46, 6
  s_mul_i32 s46, s46, 3072
  s_add_u32 m0, s51, 24576
  s_add_u32 s48, s46, s57
  buffer_load_dwordx4 v16, s[36:39], s48 offen offset:0 lds
  buffer_load_dwordx4 v17, s[36:39], s48 offen offset:1024 lds
  buffer_load_dwordx4 v18, s[36:39], s48 offen offset:2048 lds
  s_add_u32 s46, s69, 2
  s_and_b32 s46, s46, 7
  s_lshl_b32 s46, s46, 6
  s_add_u32 s46, s46, 32
  s_mul_i32 s46, s46, 3072
  s_add_u32 m0, s51, 30720
  s_add_u32 s48, s46, s57
  buffer_load_dwordx4 v16, s[36:39], s48 offen offset:0 lds
  buffer_load_dwordx4 v17, s[36:39], s48 offen offset:1024 lds
  buffer_load_dwordx4 v18, s[36:39], s48 offen offset:2048 lds
  s_add_u32 s46, s69, 3
  s_and_b32 s46, s46, 7
  s_lshl_b32 s46, s46, 7
  s_add_u32 s46, s46, s47
  s_add_u32 m0, s50, 49152
  s_mov_b32 s48, s46
  buffer_load_dwordx4 v2, s[28:31], s48 offen offset:0 lds
  s_add_u32 s48, s46, 7168
  buffer_load_dwordx4 v3, s[28:31], s48 offen offset:1024 lds
  s_add_u32 s48, s46, 14336
  buffer_load_dwordx4 v2, s[28:31], s48 offen offset:2048 lds
  s_add_u32 s48, s46, 21504
  buffer_load_dwordx4 v3, s[28:31], s48 offen offset:3072 lds
  s_add_u32 s46, s69, 3
  s_and_b32 s46, s46, 7
  s_lshl_b32 s46, s46, 7
  s_add_u32 s46, s46, s47
  s_add_u32 m0, s50, 53248
  s_add_u32 s48, s46, 32768
  buffer_load_dwordx4 v2, s[28:31], s48 offen offset:0 lds
  s_add_u32 s48, s46, 39936
  buffer_load_dwordx4 v3, s[28:31], s48 offen offset:1024 lds
  s_add_u32 s48, s46, 47104
  buffer_load_dwordx4 v2, s[28:31], s48 offen offset:2048 lds
  s_add_u32 s48, s46, 54272
  buffer_load_dwordx4 v3, s[28:31], s48 offen offset:3072 lds
  s_waitcnt vmcnt(25)
  s_barrier
  s_add_u32 s46, s69, 3
  s_and_b32 s46, s46, 7
  s_lshl_b32 s46, s46, 6
  s_mul_i32 s46, s46, 3072
  s_add_u32 m0, s51, 0
  s_add_u32 s48, s46, s57
  buffer_load_dwordx4 v16, s[36:39], s48 offen offset:0 lds
  buffer_load_dwordx4 v17, s[36:39], s48 offen offset:1024 lds
  buffer_load_dwordx4 v18, s[36:39], s48 offen offset:2048 lds
  s_waitcnt vmcnt(25)
  s_barrier
  s_add_u32 s46, s69, 3
  s_and_b32 s46, s46, 7
  s_lshl_b32 s46, s46, 6
  s_add_u32 s46, s46, 32
  s_mul_i32 s46, s46, 3072
  s_add_u32 m0, s51, 6144
  s_add_u32 s48, s46, s57
  buffer_load_dwordx4 v16, s[36:39], s48 offen offset:0 lds
  buffer_load_dwordx4 v17, s[36:39], s48 offen offset:1024 lds
  buffer_load_dwordx4 v18, s[36:39], s48 offen offset:2048 lds
  s_add_u32 s46, s69, 4
  s_and_b32 s46, s46, 7
  s_lshl_b32 s46, s46, 7
  s_add_u32 s46, s46, s47
  s_add_u32 m0, s50, 65536
  s_mov_b32 s48, s46
  buffer_load_dwordx4 v2, s[28:31], s48 offen offset:0 lds
  s_add_u32 s48, s46, 7168
  buffer_load_dwordx4 v3, s[28:31], s48 offen offset:1024 lds
  s_add_u32 s48, s46, 14336
  buffer_load_dwordx4 v2, s[28:31], s48 offen offset:2048 lds
  s_add_u32 s48, s46, 21504
  buffer_load_dwordx4 v3, s[28:31], s48 offen offset:3072 lds
  s_add_u32 s46, s69, 4
  s_and_b32 s46, s46, 7
  s_lshl_b32 s46, s46, 7
  s_add_u32 s46, s46, s47
  s_add_u32 m0, s50, 69632
  s_add_u32 s48, s46, 32768
  buffer_load_dwordx4 v2, s[28:31], s48 offen offset:0 lds
  s_add_u32 s48, s46, 39936
  buffer_load_dwordx4 v3, s[28:31], s48 offen offset:1024 lds
  s_add_u32 s48, s46, 47104
  buffer_load_dwordx4 v2, s[28:31], s48 offen offset:2048 lds
  s_add_u32 s48, s46, 54272
  buffer_load_dwordx4 v3, s[28:31], s48 offen offset:3072 lds
  s_waitcnt vmcnt(25)
  s_barrier
  s_add_u32 s46, s69, 4
  s_and_b32 s46, s46, 7
  s_lshl_b32 s46, s46, 6
  s_mul_i32 s46, s46, 3072
  s_add_u32 m0, s51, 12288
  s_add_u32 s48, s46, s57
  buffer_load_dwordx4 v16, s[36:39], s48 offen offset:0 lds
  buffer_load_dwordx4 v17, s[36:39], s48 offen offset:1024 lds
  buffer_load_dwordx4 v18, s[36:39], s48 offen offset:2048 lds
  s_waitcnt vmcnt(25)
  s_barrier
  s_add_u32 s46, s69, 4
  s_and_b32 s46, s46, 7
  s_lshl_b32 s46, s46, 6
  s_add_u32 s46, s46, 32
  s_mul_i32 s46, s46, 3072
  s_add_u32 m0, s51, 18432
  s_add_u32 s48, s46, s57
  buffer_load_dwordx4 v16, s[36:39], s48 offen offset:0 lds
  buffer_load_dwordx4 v17, s[36:39], s48 offen offset:1024 lds
  buffer_load_dwordx4 v18, s[36:39], s48 offen offset:2048 lds
  s_add_u32 s46, s69, 5
  s_and_b32 s46, s46, 7
  s_lshl_b32 s46, s46, 7
  s_add_u32 s46, s46, s47
  s_add_u32 m0, s50, 81920
  s_mov_b32 s48, s46
  buffer_load_dwordx4 v2, s[28:31], s48 offen offset:0 lds
  s_add_u32 s48, s46, 7168
  buffer_load_dwordx4 v3, s[28:31], s48 offen offset:1024 lds
  s_add_u32 s48, s46, 14336
  buffer_load_dwordx4 v2, s[28:31], s48 offen offset:2048 lds
  s_add_u32 s48, s46, 21504
  buffer_load_dwordx4 v3, s[28:31], s48 offen offset:3072 lds
  s_add_u32 s46, s69, 5
  s_and_b32 s46, s46, 7
  s_lshl_b32 s46, s46, 7
  s_add_u32 s46, s46, s47
  s_add_u32 m0, s50, 86016
  s_add_u32 s48, s46, 32768
  buffer_load_dwordx4 v2, s[28:31], s48 offen offset:0 lds
  s_add_u32 s48, s46, 39936
  buffer_load_dwordx4 v3, s[28:31], s48 offen offset:1024 lds
  s_add_u32 s48, s46, 47104
  buffer_load_dwordx4 v2, s[28:31], s48 offen offset:2048 lds
  s_add_u32 s48, s46, 54272
  buffer_load_dwordx4 v3, s[28:31], s48 offen offset:3072 lds
  s_waitcnt vmcnt(25)
  s_barrier
  s_add_u32 s46, s69, 5
  s_and_b32 s46, s46, 7
  s_lshl_b32 s46, s46, 6
  s_mul_i32 s46, s46, 3072
  s_add_u32 m0, s51, 24576
  s_add_u32 s48, s46, s57
  buffer_load_dwordx4 v16, s[36:39], s48 offen offset:0 lds
  buffer_load_dwordx4 v17, s[36:39], s48 offen offset:1024 lds
  buffer_load_dwordx4 v18, s[36:39], s48 offen offset:2048 lds
  s_waitcnt vmcnt(25)
  s_barrier
  s_add_u32 s46, s69, 5
  s_and_b32 s46, s46, 7
  s_lshl_b32 s46, s46, 6
  s_add_u32 s46, s46, 32
  s_mul_i32 s46, s46, 3072
  s_add_u32 m0, s51, 30720
  s_add_u32 s48, s46, s57
  buffer_load_dwordx4 v16, s[36:39], s48 offen offset:0 lds
  buffer_load_dwordx4 v17, s[36:39], s48 offen offset:1024 lds
  buffer_load_dwordx4 v18, s[36:39], s48 offen offset:2048 lds
  s_add_u32 s46, s69, 6
  s_and_b32 s46, s46, 7
  s_lshl_b32 s46, s46, 7
  s_add_u32 s46, s46, s47
  s_add_u32 m0, s50, 0
  s_mov_b32 s48, s46
  buffer_load_dwordx4 v2, s[28:31], s48 offen offset:0 lds
  s_add_u32 s48, s46, 7168
  buffer_load_dwordx4 v3, s[28:31], s48 offen offset:1024 lds
  s_add_u32 s48, s46, 14336
  buffer_load_dwordx4 v2, s[28:31], s48 offen offset:2048 lds
  s_add_u32 s48, s46, 21504
  buffer_load_dwordx4 v3, s[28:31], s48 offen offset:3072 lds
  s_add_u32 s46, s69, 6
  s_and_b32 s46, s46, 7
  s_lshl_b32 s46, s46, 7
  s_add_u32 s46, s46, s47
  s_add_u32 m0, s50, 4096
  s_add_u32 s48, s46, 32768
  buffer_load_dwordx4 v2, s[28:31], s48 offen offset:0 lds
  s_add_u32 s48, s46, 39936
  buffer_load_dwordx4 v3, s[28:31], s48 offen offset:1024 lds
  s_add_u32 s48, s46, 47104
  buffer_load_dwordx4 v2, s[28:31], s48 offen offset:2048 lds
  s_add_u32 s48, s46, 54272
  buffer_load_dwordx4 v3, s[28:31], s48 offen offset:3072 lds
  s_waitcnt vmcnt(25)
  s_barrier
  s_add_u32 s46, s69, 6
  s_and_b32 s46, s46, 7
  s_lshl_b32 s46, s46, 6
  s_mul_i32 s46, s46, 3072
  s_add_u32 m0, s51, 0
  s_add_u32 s48, s46, s57
  buffer_load_dwordx4 v16, s[36:39], s48 offen offset:0 lds
  buffer_load_dwordx4 v17, s[36:39], s48 offen offset:1024 lds
  buffer_load_dwordx4 v18, s[36:39], s48 offen offset:2048 lds
  s_waitcnt vmcnt(25)
  s_barrier
  s_add_u32 s46, s69, 6
  s_and_b32 s46, s46, 7
  s_lshl_b32 s46, s46, 6
  s_add_u32 s46, s46, 32
  s_mul_i32 s46, s46, 3072
  s_add_u32 m0, s51, 6144
  s_add_u32 s48, s46, s57
  buffer_load_dwordx4 v16, s[36:39], s48 offen offset:0 lds
  buffer_load_dwordx4 v17, s[36:39], s48 offen offset:1024 lds
  buffer_load_dwordx4 v18, s[36:39], s48 offen offset:2048 lds
  s_add_u32 s46, s69, 7
  s_and_b32 s46, s46, 7
  s_lshl_b32 s46, s46, 7
  s_add_u32 s46, s46, s47
  s_add_u32 m0, s50, 16384
  s_mov_b32 s48, s46
  buffer_load_dwordx4 v2, s[28:31], s48 offen offset:0 lds
  s_add_u32 s48, s46, 7168
  buffer_load_dwordx4 v3, s[28:31], s48 offen offset:1024 lds
  s_add_u32 s48, s46, 14336
  buffer_load_dwordx4 v2, s[28:31], s48 offen offset:2048 lds
  s_add_u32 s48, s46, 21504
  buffer_load_dwordx4 v3, s[28:31], s48 offen offset:3072 lds
  s_add_u32 s46, s69, 7
  s_and_b32 s46, s46, 7
  s_lshl_b32 s46, s46, 7
  s_add_u32 s46, s46, s47
  s_add_u32 m0, s50, 20480
  s_add_u32 s48, s46, 32768
  buffer_load_dwordx4 v2, s[28:31], s48 offen offset:0 lds
  s_add_u32 s48, s46, 39936
  buffer_load_dwordx4 v3, s[28:31], s48 offen offset:1024 lds
  s_add_u32 s48, s46, 47104
  buffer_load_dwordx4 v2, s[28:31], s48 offen offset:2048 lds
  s_add_u32 s48, s46, 54272
  buffer_load_dwordx4 v3, s[28:31], s48 offen offset:3072 lds
  s_waitcnt vmcnt(25)
  s_barrier
  s_add_u32 s46, s69, 7
  s_and_b32 s46, s46, 7
  s_lshl_b32 s46, s46, 6
  s_mul_i32 s46, s46, 3072
  s_add_u32 m0, s51, 12288
  s_add_u32 s48, s46, s57
  buffer_load_dwordx4 v16, s[36:39], s48 offen offset:0 lds
  buffer_load_dwordx4 v17, s[36:39], s48 offen offset:1024 lds
  buffer_load_dwordx4 v18, s[36:39], s48 offen offset:2048 lds
  s_waitcnt vmcnt(25)
  s_barrier
  s_add_u32 s46, s69, 7
  s_and_b32 s46, s46, 7
  s_lshl_b32 s46, s46, 6
  s_add_u32 s46, s46, 32
  s_mul_i32 s46, s46, 3072
  s_add_u32 m0, s51, 18432
  s_add_u32 s48, s46, s57
  buffer_load_dwordx4 v16, s[36:39], s48 offen offset:0 lds
  buffer_load_dwordx4 v17, s[36:39], s48 offen offset:1024 lds
  buffer_load_dwordx4 v18, s[36:39], s48 offen offset:2048 lds
  s_waitcnt vmcnt(17)
  s_barrier
  s_add_u32 s46, s69, 2
  s_and_b32 s46, s46, 7
  s_lshl_b32 s46, s46, 6
  s_mul_i32 s46, s46, 2752
  s_add_u32 m0, s51, 24576
  s_add_u32 s48, s46, s58
  buffer_load_dwordx4 v20, s[40:43], s48 offen offset:0 lds
  buffer_load_dwordx4 v21, s[40:43], s48 offen offset:1024 lds
  buffer_load_dwordx4 v22, s[40:43], s48 offen offset:2048 lds
  s_waitcnt vmcnt(17)
  s_barrier
  s_add_u32 s46, s69, 2
  s_and_b32 s46, s46, 7
  s_lshl_b32 s46, s46, 6
  s_add_u32 s46, s46, 32
  s_mul_i32 s46, s46, 2752
  s_add_u32 m0, s51, 30720
  s_add_u32 s48, s46, s58
  buffer_load_dwordx4 v20, s[40:43], s48 offen offset:0 lds
  buffer_load_dwordx4 v21, s[40:43], s48 offen offset:1024 lds
  buffer_load_dwordx4 v22, s[40:43], s48 offen offset:2048 lds
  s_waitcnt vmcnt(9)
  s_barrier
  s_add_u32 s46, s69, 3
  s_and_b32 s46, s46, 7
  s_lshl_b32 s46, s46, 6
  s_mul_i32 s46, s46, 2752
  s_add_u32 m0, s51, 0
  s_add_u32 s48, s46, s58
  buffer_load_dwordx4 v20, s[40:43], s48 offen offset:0 lds
  buffer_load_dwordx4 v21, s[40:43], s48 offen offset:1024 lds
  buffer_load_dwordx4 v22, s[40:43], s48 offen offset:2048 lds
  s_waitcnt vmcnt(9)
  s_barrier
  s_add_u32 s46, s69, 3
  s_and_b32 s46, s46, 7
  s_lshl_b32 s46, s46, 6
  s_add_u32 s46, s46, 32
  s_mul_i32 s46, s46, 2752
  s_add_u32 m0, s51, 6144
  s_add_u32 s48, s46, s58
  buffer_load_dwordx4 v20, s[40:43], s48 offen offset:0 lds
  buffer_load_dwordx4 v21, s[40:43], s48 offen offset:1024 lds
  buffer_load_dwordx4 v22, s[40:43], s48 offen offset:2048 lds
  s_waitcnt vmcnt(9)
  s_barrier
  s_add_u32 s46, s69, 4
  s_and_b32 s46, s46, 7
  s_lshl_b32 s46, s46, 6
  s_mul_i32 s46, s46, 2752
  s_add_u32 m0, s51, 12288
  s_add_u32 s48, s46, s58
  buffer_load_dwordx4 v20, s[40:43], s48 offen offset:0 lds
  buffer_load_dwordx4 v21, s[40:43], s48 offen offset:1024 lds
  buffer_load_dwordx4 v22, s[40:43], s48 offen offset:2048 lds
  s_waitcnt vmcnt(9)
  s_barrier
  s_add_u32 s46, s69, 4
  s_and_b32 s46, s46, 7
  s_lshl_b32 s46, s46, 6
  s_add_u32 s46, s46, 32
  s_mul_i32 s46, s46, 2752
  s_add_u32 m0, s51, 18432
  s_add_u32 s48, s46, s58
  buffer_load_dwordx4 v20, s[40:43], s48 offen offset:0 lds
  buffer_load_dwordx4 v21, s[40:43], s48 offen offset:1024 lds
  buffer_load_dwordx4 v22, s[40:43], s48 offen offset:2048 lds
  s_waitcnt vmcnt(9)
  s_barrier
  s_add_u32 s46, s69, 5
  s_and_b32 s46, s46, 7
  s_lshl_b32 s46, s46, 6
  s_mul_i32 s46, s46, 2752
  s_add_u32 m0, s51, 24576
  s_add_u32 s48, s46, s58
  buffer_load_dwordx4 v20, s[40:43], s48 offen offset:0 lds
  buffer_load_dwordx4 v21, s[40:43], s48 offen offset:1024 lds
  buffer_load_dwordx4 v22, s[40:43], s48 offen offset:2048 lds
  s_waitcnt vmcnt(9)
  s_barrier
  s_add_u32 s46, s69, 5
  s_and_b32 s46, s46, 7
  s_lshl_b32 s46, s46, 6
  s_add_u32 s46, s46, 32
  s_mul_i32 s46, s46, 2752
  s_add_u32 m0, s51, 30720
  s_add_u32 s48, s46, s58
  buffer_load_dwordx4 v20, s[40:43], s48 offen offset:0 lds
  buffer_load_dwordx4 v21, s[40:43], s48 offen offset:1024 lds
  buffer_load_dwordx4 v22, s[40:43], s48 offen offset:2048 lds
  s_waitcnt vmcnt(9)
  s_barrier
  s_add_u32 s46, s69, 6
  s_and_b32 s46, s46, 7
  s_lshl_b32 s46, s46, 6
  s_mul_i32 s46, s46, 2752
  s_add_u32 m0, s51, 0
  s_add_u32 s48, s46, s58
  buffer_load_dwordx4 v20, s[40:43], s48 offen offset:0 lds
  buffer_load_dwordx4 v21, s[40:43], s48 offen offset:1024 lds
  buffer_load_dwordx4 v22, s[40:43], s48 offen offset:2048 lds
  s_waitcnt vmcnt(9)
  s_barrier
  s_add_u32 s46, s69, 6
  s_and_b32 s46, s46, 7
  s_lshl_b32 s46, s46, 6
  s_add_u32 s46, s46, 32
  s_mul_i32 s46, s46, 2752
  s_add_u32 m0, s51, 6144
  s_add_u32 s48, s46, s58
  buffer_load_dwordx4 v20, s[40:43], s48 offen offset:0 lds
  buffer_load_dwordx4 v21, s[40:43], s48 offen offset:1024 lds
  buffer_load_dwordx4 v22, s[40:43], s48 offen offset:2048 lds
  s_waitcnt vmcnt(9)
  s_barrier
  s_add_u32 s46, s69, 7
  s_and_b32 s46, s46, 7
  s_lshl_b32 s46, s46, 6
  s_mul_i32 s46, s46, 2752
  s_add_u32 m0, s51, 12288
  s_add_u32 s48, s46, s58
  buffer_load_dwordx4 v20, s[40:43], s48 offen offset:0 lds
  buffer_load_dwordx4 v21, s[40:43], s48 offen offset:1024 lds
  buffer_load_dwordx4 v22, s[40:43], s48 offen offset:2048 lds
  s_waitcnt vmcnt(9)
  s_barrier
  s_add_u32 s46, s69, 7
  s_and_b32 s46, s46, 7
  s_lshl_b32 s46, s46, 6
  s_add_u32 s46, s46, 32
  s_mul_i32 s46, s46, 2752
  s_add_u32 m0, s51, 18432
  s_add_u32 s48, s46, s58
  buffer_load_dwordx4 v20, s[40:43], s48 offen offset:0 lds
  buffer_load_dwordx4 v21, s[40:43], s48 offen offset:1024 lds
  buffer_load_dwordx4 v22, s[40:43], s48 offen offset:2048 lds
  s_add_u32 s46, s69, 0
  s_and_b32 s46, s46, 7
  s_lshl_b32 s46, s46, 7
  s_add_u32 s46, s46, s47
  s_add_u32 m0, s50, 32768
  s_mov_b32 s48, s46
  buffer_load_dwordx4 v2, s[28:31], s48 offen offset:0 lds
  s_add_u32 s48, s46, 7168
  buffer_load_dwordx4 v3, s[28:31], s48 offen offset:1024 lds
  s_add_u32 s48, s46, 14336
  buffer_load_dwordx4 v2, s[28:31], s48 offen offset:2048 lds
  s_add_u32 s48, s46, 21504
  buffer_load_dwordx4 v3, s[28:31], s48 offen offset:3072 lds
  s_add_u32 s46, s69, 0
  s_and_b32 s46, s46, 7
  s_lshl_b32 s46, s46, 7
  s_add_u32 s46, s46, s47
  s_add_u32 m0, s50, 36864
  s_add_u32 s48, s46, 32768
  buffer_load_dwordx4 v2, s[28:31], s48 offen offset:0 lds
  s_add_u32 s48, s46, 39936
  buffer_load_dwordx4 v3, s[28:31], s48 offen offset:1024 lds
  s_add_u32 s48, s46, 47104
  buffer_load_dwordx4 v2, s[28:31], s48 offen offset:2048 lds
  s_add_u32 s48, s46, 54272
  buffer_load_dwordx4 v3, s[28:31], s48 offen offset:3072 lds
  s_waitcnt vmcnt(17)
  s_barrier
  s_add_u32 s46, s69, 0
  s_and_b32 s46, s46, 7
  s_lshl_b32 s46, s46, 6
  s_mul_i32 s46, s46, 2752
  s_add_u32 m0, s51, 24576
  s_add_u32 s48, s46, s58
  buffer_load_dwordx4 v20, s[40:43], s48 offen offset:0 lds
  buffer_load_dwordx4 v21, s[40:43], s48 offen offset:1024 lds
  buffer_load_dwordx4 v22, s[40:43], s48 offen offset:2048 lds
  s_waitcnt vmcnt(17)
  s_barrier
  s_add_u32 s46, s69, 0
  s_and_b32 s46, s46, 7
  s_lshl_b32 s46, s46, 6
  s_add_u32 s46, s46, 32
  s_mul_i32 s46, s46, 2752
  s_add_u32 m0, s51, 30720
  s_add_u32 s48, s46, s58
  buffer_load_dwordx4 v20, s[40:43], s48 offen offset:0 lds
  buffer_load_dwordx4 v21, s[40:43], s48 offen offset:1024 lds
  buffer_load_dwordx4 v22, s[40:43], s48 offen offset:2048 lds
  s_add_u32 s46, s69, 1
  s_and_b32 s46, s46, 7
  s_lshl_b32 s46, s46, 7
  s_add_u32 s46, s46, s47
  s_add_u32 m0, s50, 49152
  s_mov_b32 s48, s46
  buffer_load_dwordx4 v2, s[28:31], s48 offen offset:0 lds
  s_add_u32 s48, s46, 7168
  buffer_load_dwordx4 v3, s[28:31], s48 offen offset:1024 lds
  s_add_u32 s48, s46, 14336
  buffer_load_dwordx4 v2, s[28:31], s48 offen offset:2048 lds
  s_add_u32 s48, s46, 21504
  buffer_load_dwordx4 v3, s[28:31], s48 offen offset:3072 lds
  s_add_u32 s46, s69, 1
  s_and_b32 s46, s46, 7
  s_lshl_b32 s46, s46, 7
  s_add_u32 s46, s46, s47
  s_add_u32 m0, s50, 53248
  s_add_u32 s48, s46, 32768
  buffer_load_dwordx4 v2, s[28:31], s48 offen offset:0 lds
  s_add_u32 s48, s46, 39936
  buffer_load_dwordx4 v3, s[28:31], s48 offen offset:1024 lds
  s_add_u32 s48, s46, 47104
  buffer_load_dwordx4 v2, s[28:31], s48 offen offset:2048 lds
  s_add_u32 s48, s46, 54272
  buffer_load_dwordx4 v3, s[28:31], s48 offen offset:3072 lds
  s_waitcnt vmcnt(25)
  s_barrier
  s_add_u32 s46, s69, 1
  s_and_b32 s46, s46, 7
  s_lshl_b32 s46, s46, 6
  s_mul_i32 s46, s46, 2752
  s_add_u32 m0, s51, 0
  s_add_u32 s48, s46, s58
  buffer_load_dwordx4 v20, s[40:43], s48 offen offset:0 lds
  buffer_load_dwordx4 v21, s[40:43], s48 offen offset:1024 lds
  buffer_load_dwordx4 v22, s[40:43], s48 offen offset:2048 lds
  s_waitcnt vmcnt(25)
  s_barrier
  s_add_u32 s46, s69, 1
  s_and_b32 s46, s46, 7
  s_lshl_b32 s46, s46, 6
  s_add_u32 s46, s46, 32
  s_mul_i32 s46, s46, 2752
  s_add_u32 m0, s51, 6144
  s_add_u32 s48, s46, s58
  buffer_load_dwordx4 v20, s[40:43], s48 offen offset:0 lds
  buffer_load_dwordx4 v21, s[40:43], s48 offen offset:1024 lds
  buffer_load_dwordx4 v22, s[40:43], s48 offen offset:2048 lds
  s_waitcnt vmcnt(17)
  s_barrier
  s_waitcnt vmcnt(14)
  s_barrier
  s_waitcnt vmcnt(3)
  s_barrier
  s_waitcnt vmcnt(0)
  s_barrier
  s_barrier
  s_branch L_postE1
L_jobwave:
  s_sub_u32 s54, s26, 6
  s_lshr_b32 s65, s2, 2
  s_cmp_ge_u32 s65, 24
  s_cbranch_scc1 L_pcs1
  s_mov_b32 s72, s6
  s_and_b32 s73, s7, 0xffff
  s_mov_b32 s74, 0x180000
  s_mov_b32 s75, 0x20000
  s_movk_i32 s66, 3072
  s_lshl_b32 s67, s65, 7
  s_branch L_pcs2
L_pcs1:
  s_mov_b32 s72, s12
  s_and_b32 s73, s13, 0xffff
  s_mov_b32 s74, 0x158000
  s_mov_b32 s75, 0x20000
  s_movk_i32 s66, 2752
  s_sub_u32 s67, s65, 24
  s_lshl_b32 s67, s67, 7
L_pcs2:
  v_lshrrev_b32 v2, 3, v1
  v_mul_lo_u32 v2, v2, s66
  v_and_b32 v3, 7, v1
  v_lshl_add_u32 v2, v3, 4, v2
  s_and_b32 s46, s2, 3
  s_lshl_b32 s46, s46, 7
  s_lshl_b32 s48, s54, 6
  s_add_u32 s46, s46, s48
  s_mul_i32 s46, s46, s66
  s_add_u32 s67, s67, s46
  s_lshl_b32 s66, s66, 3
  v_lshlrev_b32 v4, 20, v1
  s_mov_b32 exec_lo, 0x1ffff
  s_mov_b32 exec_hi, 0
  buffer_load_dword v61, v4, s[32:35], 0 offen sc1
  s_mov_b64 exec, -1
  v_mov_b32 v4, 0
  v_mov_b32 v5, 160192
  ds_write_b32 v5, v4
  ds_write_b32 v5, v4 offset:4
  s_waitcnt lgkmcnt(0)
  s_setprio 2
  buffer_load_dwordx4 v[64:67], v2, s[72:75], s67 offen
  s_add_u32 s67, s67, s66
  buffer_load_dwordx4 v[68:71], v2, s[72:75], s67 offen
  s_add_u32 s67, s67, s66
  buffer_load_dwordx4 v[72:75], v2, s[72:75], s67 offen
  s_add_u32 s67, s67, s66
  buffer_load_dwordx4 v[76:79], v2, s[72:75], s67 offen
  s_add_u32 s67, s67, s66
  buffer_load_dwordx4 v[80:83], v2, s[72:75], s67 offen
  s_add_u32 s67, s67, s66
  buffer_load_dwordx4 v[84:87], v2, s[72:75], s67 offen
  s_add_u32 s67, s67, s66
  buffer_load_dwordx4 v[88:91], v2, s[72:75], s67 offen
  s_add_u32 s67, s67, s66
  buffer_load_dwordx4 v[92:95], v2, s[72:75], s67 offen
  s_add_u32 s67, s67, s66
  s_barrier
  s_mov_b32 s72, s22
  s_and_b32 s73, s23, 0xffff
  s_mov_b32 s74, 0x100
  s_mov_b32 s75, 0x20000
  v_mov_b32 v7, 0
  buffer_load_dword v60, v7, s[72:75], 0 offen sc1
  s_waitcnt vmcnt(1)
  v_lshlrev_b32 v16, 16, v64
  v_and_b32 v17, 0xffff0000, v64
  v_lshlrev_b32 v18, 16, v65
  v_and_b32 v19, 0xffff0000, v65
  v_lshlrev_b32 v20, 16, v66
  v_and_b32 v21, 0xffff0000, v66
  v_lshlrev_b32 v22, 16, v67
  v_and_b32 v23, 0xffff0000, v67
  v_mov_b32 v48, v16
  v_mov_b32 v49, v17
  v_mov_b32 v50, v18
  v_mov_b32 v51, v19
  v_mov_b32 v52, v20
  v_mov_b32 v53, v21
  v_mov_b32 v54, v22
  v_mov_b32 v55, v23
  v_lshlrev_b32 v16, 16, v68
  v_and_b32 v17, 0xffff0000, v68
  v_lshlrev_b32 v18, 16, v69
  v_and_b32 v19, 0xffff0000, v69
  v_lshlrev_b32 v20, 16, v70
  v_and_b32 v21, 0xffff0000, v70
  v_lshlrev_b32 v22, 16, v71
  v_and_b32 v23, 0xffff0000, v71
  v_pk_add_f32 v[48:49], v[48:49], v[16:17]
  v_pk_add_f32 v[50:51], v[50:51], v[18:19]
  v_pk_add_f32 v[52:53], v[52:53], v[20:21]
  v_pk_add_f32 v[54:55], v[54:55], v[22:23]
  s_barrier
  v_lshlrev_b32 v16, 16, v72
  v_and_b32 v17, 0xffff0000, v72
  v_lshlrev_b32 v18, 16, v73
  v_and_b32 v19, 0xffff0000, v73
  v_lshlrev_b32 v20, 16, v74
  v_and_b32 v21, 0xffff0000, v74
  v_lshlrev_b32 v22, 16, v75
  v_and_b32 v23, 0xffff0000, v75
  v_pk_add_f32 v[48:49], v[48:49], v[16:17]
  v_pk_add_f32 v[50:51], v[50:51], v[18:19]
  v_pk_add_f32 v[52:53], v[52:53], v[20:21]
  v_pk_add_f32 v[54:55], v[54:55], v[22:23]
  v_lshlrev_b32 v16, 16, v76
  v_and_b32 v17, 0xffff0000, v76
  v_lshlrev_b32 v18, 16, v77
  v_and_b32 v19, 0xffff0000, v77
  v_lshlrev_b32 v20, 16, v78
  v_and_b32 v21, 0xffff0000, v78
  v_lshlrev_b32 v22, 16, v79
  v_and_b32 v23, 0xffff0000, v79
  v_pk_add_f32 v[48:49], v[48:49], v[16:17]
  v_pk_add_f32 v[50:51], v[50:51], v[18:19]
  v_pk_add_f32 v[52:53], v[52:53], v[20:21]
  v_pk_add_f32 v[54:55], v[54:55], v[22:23]
  v_lshlrev_b32 v16, 16, v80
  v_and_b32 v17, 0xffff0000, v80
  v_lshlrev_b32 v18, 16, v81
  v_and_b32 v19, 0xffff0000, v81
  v_lshlrev_b32 v20, 16, v82
  v_and_b32 v21, 0xffff0000, v82
  v_lshlrev_b32 v22, 16, v83
  v_and_b32 v23, 0xffff0000, v83
  v_pk_add_f32 v[48:49], v[48:49], v[16:17]
  v_pk_add_f32 v[50:51], v[50:51], v[18:19]
  v_pk_add_f32 v[52:53], v[52:53], v[20:21]
  v_pk_add_f32 v[54:55], v[54:55], v[22:23]
  s_barrier
  v_lshlrev_b32 v16, 16, v84
  v_and_b32 v17, 0xffff0000, v84
  v_lshlrev_b32 v18, 16, v85
  v_and_b32 v19, 0xffff0000, v85
  v_lshlrev_b32 v20, 16, v86
  v_and_b32 v21, 0xffff0000, v86
  v_lshlrev_b32 v22, 16, v87
  v_and_b32 v23, 0xffff0000, v87
  v_pk_add_f32 v[48:49], v[48:49], v[16:17]
  v_pk_add_f32 v[50:51], v[50:51], v[18:19]
  v_pk_add_f32 v[52:53], v[52:53], v[20:21]
  v_pk_add_f32 v[54:55], v[54:55], v[22:23]
  v_lshlrev_b32 v16, 16, v88
  v_and_b32 v17, 0xffff0000, v88
  v_lshlrev_b32 v18, 16, v89
  v_and_b32 v19, 0xffff0000, v89
  v_lshlrev_b32 v20, 16, v90
  v_and_b32 v21, 0xffff0000, v90
  v_lshlrev_b32 v22, 16, v91
  v_and_b32 v23, 0xffff0000, v91
  v_pk_add_f32 v[48:49], v[48:49], v[16:17]
  v_pk_add_f32 v[50:51], v[50:51], v[18:19]
  v_pk_add_f32 v[52:53], v[52:53], v[20:21]
  v_pk_add_f32 v[54:55], v[54:55], v[22:23]
  v_lshlrev_b32 v16, 16, v92
  v_and_b32 v17, 0xffff0000, v92
  v_lshlrev_b32 v18, 16, v93
  v_and_b32 v19, 0xffff0000, v93
  v_lshlrev_b32 v20, 16, v94
  v_and_b32 v21, 0xffff0000, v94
  v_lshlrev_b32 v22, 16, v95
  v_and_b32 v23, 0xffff0000, v95
  v_pk_add_f32 v[48:49], v[48:49], v[16:17]
  v_pk_add_f32 v[50:51], v[50:51], v[18:19]
  v_pk_add_f32 v[52:53], v[52:53], v[20:21]
  v_pk_add_f32 v[54:55], v[54:55], v[22:23]
  s_barrier
  s_nop 1
  v_add_f32_dpp v48, v48, v48 row_shr:8 row_mask:0xf bank_mask:0xf
  v_add_f32_dpp v49, v49, v49 row_shr:8 row_mask:0xf bank_mask:0xf
  v_add_f32_dpp v50, v50, v50 row_shr:8 row_mask:0xf bank_mask:0xf
  v_add_f32_dpp v51, v51, v51 row_shr:8 row_mask:0xf bank_mask:0xf
  v_add_f32_dpp v52, v52, v52 row_shr:8 row_mask:0xf bank_mask:0xf
  v_add_f32_dpp v53, v53, v53 row_shr:8 row_mask:0xf bank_mask:0xf
  v_add_f32_dpp v54, v54, v54 row_shr:8 row_mask:0xf bank_mask:0xf
  v_add_f32_dpp v55, v55, v55 row_shr:8 row_mask:0xf bank_mask:0xf
  v_lshrrev_b32 v16, 4, v1
  s_lshl_b32 s46, s54, 2
  v_add_u32 v16, s46, v16
  v_lshlrev_b32 v16, 8, v16
  v_and_b32 v17, 7, v1
  v_lshl_add_u32 v16, v17, 5, v16
  v_add_u32 v16, 135168, v16
  s_mov_b32 exec_lo, 0xff00ff00
  s_mov_b32 exec_hi, 0xff00ff00
  ds_write_b128 v16, v[48:51]
  ds_write_b128 v16, v[52:55] offset:16
  s_mov_b64 exec, -1
  s_waitcnt lgkmcnt(0)
  v_mov_b32 v7, 0
  s_cmp_lg_u32 s54, 0
  s_cbranch_scc1 L_epd_3
  s_waitcnt vmcnt(0)
  v_readfirstlane_b32 s27, v60
  s_mov_b32 s46, 0
L_ep_2:
  s_cmp_lg_u32 s27, 0
  s_cbranch_scc1 L_epd_3
  s_add_u32 s46, s46, 1
  s_cmp_ge_u32 s46, 131072
  s_cbranch_scc1 L_epd_3
  buffer_load_dword v60, v7, s[72:75], 0 offen sc1
  s_waitcnt vmcnt(0)
  v_readfirstlane_b32 s27, v60
  s_branch L_ep_2
L_epd_3:
  s_barrier
  v_lshlrev_b32 v16, 2, v1
  s_cmp_lg_u32 s54, 0
  s_cbranch_scc1 L_cs3_4
  s_cmp_ge_u32 s2, 184
  s_cbranch_scc1 L_cs3_4
  v_add_u32 v17, 135168, v16
  ds_read_b32 v64, v17 offset:0
  ds_read_b32 v65, v17 offset:256
  ds_read_b32 v66, v17 offset:512
  ds_read_b32 v67, v17 offset:768
  ds_read_b32 v68, v17 offset:1024
  ds_read_b32 v69, v17 offset:1280
  ds_read_b32 v70, v17 offset:1536
  ds_read_b32 v71, v17 offset:1792
  s_and_b32 s46, s2, 3
  s_mul_i32 s46, s46, 12288
  s_lshl_b32 s48, s65, 8
  s_add_u32 s46, s46, s48
  s_add_u32 s46, s46, 2031616
  s_waitcnt lgkmcnt(0)
  v_add_f32 v64, v64, v68
  v_add_f32 v65, v65, v69
  v_add_f32 v66, v66, v70
  v_add_f32 v67, v67, v71
  v_add_f32 v64, v64, v66
  v_add_f32 v65, v65, v67
  v_add_f32 v64, v64, v65
  buffer_store_dword v64, v16, s[32:35], s46 offen sc1
L_cs3_4:
  v_lshrrev_b32 v30, 4, v1
  v_lshlrev_b32 v30, 10, v30
  v_and_b32 v31, 15, v1
  v_lshl_add_u32 v30, v31, 4, v30
  v_lshlrev_b32 v31, 4, v1
  s_cmp_eq_u32 s54, 1
  s_cbranch_scc0 L_wjs0_5
  s_cmp_ge_u32 s2, 64
  s_cbranch_scc1 L_wjs1_6
  s_mov_b32 s72, s8
  s_and_b32 s73, s9, 0xffff
  s_mov_b32 s74, 0x80000
  s_mov_b32 s75, 0x20000
  s_movk_i32 s3, 1024
  s_mov_b32 s66, 8
  s_mov_b32 s55, 0
  s_branch L_wjs2_7
L_wjs1_6:
  s_mov_b32 s72, s16
  s_and_b32 s73, s17, 0xffff
  s_mov_b32 s74, 0x158000
  s_mov_b32 s75, 0x20000
  s_movk_i32 s3, 2048
  s_mov_b32 s66, 4
  s_mov_b32 s55, 32
L_wjs2_7:
  s_lshl_b32 s46, s2, 1
  s_add_u32 s46, s46, 0
  s_and_b32 s47, s46, 3
  s_lshr_b32 s48, s46, 2
  s_sub_u32 s49, s48, s55
  s_lshl_b32 s49, s49, 14
  s_lshl_b32 s50, s47, 8
  s_add_u32 s56, s49, s50
  s_lshl_b32 s47, s47, 2
  s_mul_i32 s47, s47, 118
  s_add_u32 s47, s47, s48
  s_lshl_b32 s47, s47, 10
  s_add_u32 s60, s47, 65536
  s_cmp_ge_u32 s46, 472
  s_cselect_b32 s56, 2147418112, s56
  s_cselect_b32 s60, 2147418112, s60
  s_lshl_b32 s46, s2, 1
  s_add_u32 s46, s46, 1
  s_and_b32 s47, s46, 3
  s_lshr_b32 s48, s46, 2
  s_sub_u32 s49, s48, s55
  s_lshl_b32 s49, s49, 14
  s_lshl_b32 s50, s47, 8
  s_add_u32 s57, s49, s50
  s_lshl_b32 s47, s47, 2
  s_mul_i32 s47, s47, 118
  s_add_u32 s47, s47, s48
  s_lshl_b32 s47, s47, 10
  s_add_u32 s61, s47, 65536
  s_cmp_ge_u32 s46, 472
  s_cselect_b32 s57, 2147418112, s57
  s_cselect_b32 s61, 2147418112, s61
L_wjs0_5:
  s_barrier
  s_cmp_eq_u32 s54, 1
  s_cbranch_scc0 L_wjl_8
  s_mov_b32 m0, 137216
  s_add_u32 s46, s56, 0
  buffer_load_dwordx4 v30, s[72:75], s46 offen lds
L_wjl_8:
  s_barrier
  s_cmp_lg_u32 s54, 0
  s_cbranch_scc1 L_dr6_9
  s_waitcnt vmcnt(0)
L_dr6_9:
  s_cmp_eq_u32 s54, 1
  s_cbranch_scc0 L_wjl_10
  s_mov_b32 m0, 138240
  s_add_u32 s46, s56, 4096
  buffer_load_dwordx4 v30, s[72:75], s46 offen lds
L_wjl_10:
  s_barrier
  s_cmp_lg_u32 s54, 0
  s_cbranch_scc1 L_f0_11
  s_lshl_b32 s46, s2, 7
  s_add_u32 s46, s46, 16777216
  v_mov_b32 v28, s27
  v_mov_b32 v29, 0
  s_mov_b64 exec, 1
  buffer_store_dword v28, v29, s[32:35], s46 offen sc1
  s_mov_b64 exec, -1
  s_nop 0
L_f0_11:
  s_cmp_eq_u32 s54, 1
  s_cbranch_scc0 L_wjl_12
  s_mov_b32 m0, 139264
  s_add_u32 s46, s56, 8192
  buffer_load_dwordx4 v30, s[72:75], s46 offen lds
L_wjl_12:
  s_barrier
  s_cmp_eq_u32 s54, 1
  s_cbranch_scc0 L_wjl_13
  s_mov_b32 m0, 140288
  s_add_u32 s46, s56, 12288
  buffer_load_dwordx4 v30, s[72:75], s46 offen lds
L_wjl_13:
  s_barrier
  s_cmp_eq_u32 s54, 1
  s_cbranch_scc0 L_wjl_14
  s_mov_b32 m0, 141312
  s_add_u32 s46, s57, 0
  buffer_load_dwordx4 v30, s[72:75], s46 offen lds
L_wjl_14:
  s_barrier
  s_cmp_eq_u32 s54, 1
  s_cbranch_scc0 L_wjl_15
  s_mov_b32 m0, 142336
  s_add_u32 s46, s57, 4096
  buffer_load_dwordx4 v30, s[72:75], s46 offen lds
L_wjl_15:
  s_barrier
  s_lshl_b32 s46, s44, 4
  v_add_u32 v20, s46, v1
  s_mul_i32 s46, s45, 3
  s_lshr_b32 s46, s46, 1
  s_lshl_b32 s46, s46, 2
  s_sub_u32 s46, s46, 16
  v_add_u32 v21, s46, v1
  s_lshl_b32 s46, s53, 4
  s_add_u32 s46, s46, 1536
  s_lshr_b32 s46, s46, 6
  s_lshl_b32 s46, s46, 2
  s_sub_u32 s46, s46, 28
  v_add_u32 v22, s46, v1
  v_cmp_gt_u32 s[62:63], 28, v1
  v_cmp_gt_u32 vcc, 16, v1
  s_nop 1
  v_cndmask_b32 v21, v22, v21, s[62:63]
  v_cndmask_b32 v20, v21, v20, vcc
  v_min_u32 v20, 255, v20
  s_lshl_b32 s46, s44, 4
  v_mov_b32 v21, s46
  v_cmp_gt_u32 vcc, 40, v1
  s_nop 1
  v_cndmask_b32 v20, v21, v20, vcc
  v_lshlrev_b32 v62, 7, v20
  s_cmp_lg_u32 s54, 0
  s_cbranch_scc1 L_c0_16
  s_mov_b32 s59, 16777216
  buffer_load_dword v88, v62, s[32:35], s59 offen sc1
L_c0_16:
  s_cmp_eq_u32 s54, 1
  s_cbranch_scc0 L_wjl_17
  s_mov_b32 m0, 143360
  s_add_u32 s46, s57, 8192
  buffer_load_dwordx4 v30, s[72:75], s46 offen lds
L_wjl_17:
  s_barrier
  s_cmp_eq_u32 s54, 1
  s_cbranch_scc0 L_wjl_18
  s_mov_b32 m0, 144384
  s_add_u32 s46, s57, 12288
  buffer_load_dwordx4 v30, s[72:75], s46 offen lds
L_wjl_18:
  s_barrier
  v_lshlrev_b32 v16, 4, v1
  v_lshlrev_b32 v17, 3, v1
  v_lshlrev_b32 v18, 2, v1
  s_mov_b32 s71, 0
  s_cmp_lg_u32 s54, 0
  s_cbranch_scc1 L_c1_19
  s_waitcnt vmcnt(0)
  v_cmp_ne_u32 vcc, s27, v88
  s_nop 4
  s_cbranch_vccnz L_c1_19
  s_mov_b32 s71, 1
  s_lshl_b32 s46, s44, 11
  s_add_u32 s46, s46, 0
  buffer_load_dwordx4 v[64:67], v16, s[32:35], s46 offen sc1
  buffer_load_dwordx4 v[68:71], v16, s[32:35], s46 offen offset:1024 sc1
  s_mul_i32 s61, s45, 384
  s_add_u32 s61, s61, 2031616
  s_lshl_b32 s60, s53, 6
  s_add_u32 s60, s60, 2037760
  buffer_load_dwordx2 v[72:73], v17, s[32:35], s61 offen sc1
  buffer_load_dwordx2 v[92:93], v17, s[32:35], s60 offen sc1
  s_add_u32 s61, s61, 12288
  s_add_u32 s60, s60, 12288
  buffer_load_dwordx2 v[74:75], v17, s[32:35], s61 offen sc1
  buffer_load_dwordx2 v[94:95], v17, s[32:35], s60 offen sc1
  s_add_u32 s61, s61, 12288
  s_add_u32 s60, s60, 12288
  buffer_load_dwordx2 v[76:77], v17, s[32:35], s61 offen sc1
  buffer_load_dwordx2 v[96:97], v17, s[32:35], s60 offen sc1
  s_add_u32 s61, s61, 12288
  s_add_u32 s60, s60, 12288
  buffer_load_dwordx2 v[78:79], v17, s[32:35], s61 offen sc1
  buffer_load_dwordx2 v[98:99], v17, s[32:35], s60 offen sc1
  s_add_u32 s61, s61, 12288
  s_add_u32 s60, s60, 12288
  s_mov_b32 s72, s14
  s_and_b32 s73, s15, 0xffff
  s_mov_b32 s74, 0xac0
  s_mov_b32 s75, 0x20000
  s_lshl_b32 s46, s53, 5
  buffer_load_dword v84, v18, s[72:75], s46 offen
L_c1_19:
  s_barrier
  s_barrier
  s_barrier
  v_lshlrev_b32 v16, 4, v1
  v_lshlrev_b32 v17, 3, v1
  v_lshlrev_b32 v18, 2, v1
  s_cmp_lg_u32 s54, 0
  s_cbranch_scc1 L_c2_20
  s_cmp_eq_u32 s71, 1
  s_cbranch_scc1 L_c2w_21
  s_mov_b32 s59, 16777216
  s_mov_b32 s46, 0
L_pf0_22:
  buffer_load_dword v88, v62, s[32:35], s59 offen sc1
  s_waitcnt vmcnt(0)
  v_cmp_ne_u32 vcc, s27, v88
  s_add_u32 s46, s46, 1
  s_cmp_ge_u32 s46, 131072
  s_cbranch_scc1 L_pf0_d_23
  s_nop 1
  s_cbranch_vccnz L_pf0_22
L_pf0_d_23:
  s_lshl_b32 s46, s44, 11
  s_add_u32 s46, s46, 0
  buffer_load_dwordx4 v[64:67], v16, s[32:35], s46 offen sc1
  buffer_load_dwordx4 v[68:71], v16, s[32:35], s46 offen offset:1024 sc1
  s_mul_i32 s61, s45, 384
  s_add_u32 s61, s61, 2031616
  s_lshl_b32 s60, s53, 6
  s_add_u32 s60, s60, 2037760
  buffer_load_dwordx2 v[72:73], v17, s[32:35], s61 offen sc1
  buffer_load_dwordx2 v[92:93], v17, s[32:35], s60 offen sc1
  s_add_u32 s61, s61, 12288
  s_add_u32 s60, s60, 12288
  buffer_load_dwordx2 v[74:75], v17, s[32:35], s61 offen sc1
  buffer_load_dwordx2 v[94:95], v17, s[32:35], s60 offen sc1
  s_add_u32 s61, s61, 12288
  s_add_u32 s60, s60, 12288
  buffer_load_dwordx2 v[76:77], v17, s[32:35], s61 offen sc1
  buffer_load_dwordx2 v[96:97], v17, s[32:35], s60 offen sc1
  s_add_u32 s61, s61, 12288
  s_add_u32 s60, s60, 12288
  buffer_load_dwordx2 v[78:79], v17, s[32:35], s61 offen sc1
  buffer_load_dwordx2 v[98:99], v17, s[32:35], s60 offen sc1
  s_add_u32 s61, s61, 12288
  s_add_u32 s60, s60, 12288
  s_mov_b32 s72, s14
  s_and_b32 s73, s15, 0xffff
  s_mov_b32 s74, 0xac0
  s_mov_b32 s75, 0x20000
  s_lshl_b32 s46, s53, 5
  buffer_load_dword v84, v18, s[72:75], s46 offen
L_c2w_21:
  s_waitcnt vmcnt(0)
  v_add_u32 v16, 160256, v16
  ds_write_b128 v16, v[64:67]
  ds_write_b128 v16, v[68:71] offset:1024
  v_add_f32 v72, v72, v74
  v_add_f32 v73, v73, v75
  v_add_f32 v92, v92, v94
  v_add_f32 v93, v93, v95
  v_add_f32 v72, v72, v76
  v_add_f32 v73, v73, v77
  v_add_f32 v92, v92, v96
  v_add_f32 v93, v93, v97
  v_add_f32 v72, v72, v78
  v_add_f32 v73, v73, v79
  v_add_f32 v92, v92, v98
  v_add_f32 v93, v93, v99
  v_add_u32 v19, 162304, v17
  v_lshlrev_b32 v78, 16, v84
  v_and_b32 v79, 0xffff0000, v84
  s_mov_b32 exec_hi, 0xffff
  ds_write_b64 v19, v[72:73]
  ds_write_b64 v19, v[92:93] offset:384
  ds_write_b64 v19, v[78:79] offset:896
  s_mov_b64 exec, -1
  s_waitcnt lgkmcnt(0)
L_c2_20:
  s_barrier
  s_barrier
  v_lshrrev_b32 v28, 5, v1
  v_mul_lo_u32 v28, v28, s66
  v_bfe_u32 v29, v1, 2, 2
  v_add_u32 v28, v28, v29
  v_lshlrev_b32 v28, 8, v28
  v_bfe_u32 v29, v1, 4, 1
  v_lshl_add_u32 v28, v29, 5, v28
  v_and_b32 v29, 3, v1
  v_lshl_add_u32 v28, v29, 3, v28
  v_add_u32 v28, 137216, v28
  v_add_u32 v29, s3, v28
  s_cmp_eq_u32 s54, 1
  s_cbranch_scc0 L_wjr_24
  s_waitcnt vmcnt(0)
  ds_read_b64_tr_b16 v[96:97], v28 offset:0
  ds_read_b64_tr_b16 v[98:99], v29 offset:0
  ds_read_b64_tr_b16 v[100:101], v28 offset:64
  ds_read_b64_tr_b16 v[102:103], v29 offset:64
  ds_read_b64_tr_b16 v[104:105], v28 offset:128
  ds_read_b64_tr_b16 v[106:107], v29 offset:128
  ds_read_b64_tr_b16 v[108:109], v28 offset:192
  ds_read_b64_tr_b16 v[110:111], v29 offset:192
  ds_read_b64_tr_b16 v[112:113], v28 offset:4096
  ds_read_b64_tr_b16 v[114:115], v29 offset:4096
  ds_read_b64_tr_b16 v[116:117], v28 offset:4160
  ds_read_b64_tr_b16 v[118:119], v29 offset:4160
  ds_read_b64_tr_b16 v[120:121], v28 offset:4224
  ds_read_b64_tr_b16 v[122:123], v29 offset:4224
  ds_read_b64_tr_b16 v[124:125], v28 offset:4288
  ds_read_b64_tr_b16 v[126:127], v29 offset:4288
  s_waitcnt lgkmcnt(0)
L_wjr_24:
  s_barrier
  s_cmp_eq_u32 s54, 1
  s_cbranch_scc0 L_wjs_25
  s_add_u32 s46, s60, 0
  buffer_store_dwordx4 v[96:99], v31, s[32:35], s46 offen sc1
L_wjs_25:
  s_barrier
  s_cmp_eq_u32 s54, 1
  s_cbranch_scc0 L_wjs_26
  s_add_u32 s46, s60, 120832
  buffer_store_dwordx4 v[100:103], v31, s[32:35], s46 offen sc1
L_wjs_26:
  s_barrier
  s_cmp_eq_u32 s54, 1
  s_cbranch_scc0 L_wjs_27
  s_add_u32 s46, s60, 241664
  buffer_store_dwordx4 v[104:107], v31, s[32:35], s46 offen sc1
L_wjs_27:
  s_barrier
  s_cmp_eq_u32 s54, 1
  s_cbranch_scc0 L_wjs_28
  s_add_u32 s46, s60, 362496
  buffer_store_dwordx4 v[108:111], v31, s[32:35], s46 offen sc1
L_wjs_28:
  s_barrier
  s_cmp_eq_u32 s54, 1
  s_cbranch_scc0 L_wjs_29
  s_add_u32 s46, s61, 0
  buffer_store_dwordx4 v[112:115], v31, s[32:35], s46 offen sc1
L_wjs_29:
  s_barrier
  s_cmp_eq_u32 s54, 1
  s_cbranch_scc0 L_wjs_30
  s_add_u32 s46, s61, 120832
  buffer_store_dwordx4 v[116:119], v31, s[32:35], s46 offen sc1
L_wjs_30:
  s_barrier
  s_cmp_eq_u32 s54, 1
  s_cbranch_scc0 L_wjs_31
  s_add_u32 s46, s61, 241664
  buffer_store_dwordx4 v[120:123], v31, s[32:35], s46 offen sc1
L_wjs_31:
  s_barrier
  s_cmp_lg_u32 s54, 0
  s_cbranch_scc1 L_fa_32
  s_lshl_b32 s46, s45, 4
  s_add_u32 s46, s46, s44
  s_lshl_b32 s46, s46, 7
  s_add_u32 s46, s46, 16809984
  v_mov_b32 v28, s27
  v_mov_b32 v29, 0
  s_mov_b64 exec, 1
  buffer_store_dword v28, v29, s[32:35], s46 offen sc1
  s_mov_b64 exec, -1
  s_nop 0
L_fa_32:
  s_cmp_eq_u32 s54, 1
  s_cbranch_scc0 L_wjs_33
  s_add_u32 s46, s61, 362496
  buffer_store_dwordx4 v[124:127], v31, s[32:35], s46 offen sc1
L_wjs_33:
  s_barrier
  s_barrier
  s_waitcnt vmcnt(0)
  s_barrier
  s_barrier
  s_and_b32 s46, s2, 7
  s_lshr_b32 s47, s2, 3
  s_and_b32 s47, s47, 3
  s_lshl_b32 s46, s46, 2
  s_add_u32 s47, s47, s46
  v_lshrrev_b32 v59, 4, v1
  v_min_u32 v59, 2, v59
  v_lshlrev_b32 v59, 5, v59
  v_add_u32 v59, s47, v59
  v_mul_u32_u24 v59, 43, v59
  v_lshrrev_b32 v59, 8, v59
  v_and_b32 v58, 15, v1
  v_lshl_add_u32 v59, v59, 4, v58
  v_lshlrev_b32 v59, 7, v59
  s_cmp_lg_u32 s54, 0
  s_cbranch_scc1 L_fai_34
  s_mov_b32 s46, 16809984
  buffer_load_dword v58, v59, s[32:35], s46 offen sc1
L_fai_34:
  s_barrier
  s_barrier
  v_mov_b32 v20, 0x3f80
  v_mov_b32 v21, 0
  v_mov_b32 v22, 0
  v_mov_b32 v23, 0
  v_mov_b32 v24, 0
  v_mov_b32 v25, 0
  v_mov_b32 v26, 0
  v_mov_b32 v27, 0
  v_lshlrev_b32 v3, 5, v0
  v_add_u32 v3, 118784, v3
  ds_write_b128 v3, v[20:23]
  ds_write_b128 v3, v[24:27] offset:16
  s_waitcnt lgkmcnt(0)
  s_setprio 0
L_postE1:
  s_sub_u32 s54, s26, 4
  s_and_b32 s46, s2, 7
  s_lshr_b32 s47, s2, 3
  s_and_b32 s56, s47, 3
  s_lshl_b32 s46, s46, 2
  s_add_u32 s56, s56, s46
  s_lshr_b32 s57, s47, 2
  v_lshrrev_b32 v16, 4, v1
  v_min_u32 v16, 2, v16
  v_lshlrev_b32 v16, 5, v16
  v_add_u32 v16, s56, v16
  v_mul_u32_u24 v16, 43, v16
  v_lshrrev_b32 v16, 8, v16
  v_and_b32 v17, 15, v1
  v_lshl_add_u32 v16, v16, 4, v17
  v_lshlrev_b32 v16, 7, v16
  v_mov_b32 v24, 160192
  v_mov_b32 v25, 1
  v_lshlrev_b32 v2, 4, v1
  s_lshl_b32 s58, s56, 16
  s_and_b32 s47, s54, 1
  s_lshl_b32 s48, s47, 21
  s_add_u32 s58, s58, s48
  s_add_u32 s58, s58, 4194304
  s_lshr_b32 s48, s54, 1
  s_lshl_b32 s48, s48, 15
  s_add_u32 s58, s58, s48
  s_lshl_b32 s47, s47, 16
  s_add_u32 s47, s47, s48
  s_lshl_b32 s48, s56, 6
  s_lshl_b32 s49, s57, 3
  s_add_u32 s48, s48, s49
  s_lshl_b32 s49, s54, 1
  s_add_u32 s48, s48, s49
  s_lshl_b32 s48, s48, 10
  s_add_u32 s48, s48, 2097152
  s_lshl_b32 s49, s54, 11
  s_cmp_eq_u32 s26, 6
  s_cbranch_scc0 L_faw_35
  s_waitcnt vmcnt(0)
  v_cmp_ne_u32 vcc, s27, v58
  s_nop 4
  s_cbranch_vccz L_faok_37
  s_mov_b32 s59, 16809984
  s_mov_b32 s46, 0
L_pfa_38:
  buffer_load_dword v17, v16, s[32:35], s59 offen sc1
  s_waitcnt vmcnt(0)
  v_cmp_ne_u32 vcc, s27, v17
  s_add_u32 s46, s46, 1
  s_cmp_ge_u32 s46, 131072
  s_cbranch_scc1 L_pfa_d_39
  s_nop 1
  s_cbranch_vccnz L_pfa_38
L_pfa_d_39:
L_faok_37:
  ds_write_b32 v24, v25
  s_branch L_fag_36
L_faw_35:
  s_mov_b32 s46, 0
L_fas_40:
  ds_read_b32 v26, v24
  s_waitcnt lgkmcnt(0)
  v_readfirstlane_b32 s59, v26
  s_add_u32 s46, s46, 1
  s_cmp_ge_u32 s46, 2097152
  s_cbranch_scc1 L_fag_36
  s_cmp_eq_u32 s59, 0
  s_cbranch_scc1 L_fas_40
L_fag_36:
  s_add_u32 m0, s49, 151552
  s_nop 0
  buffer_load_dwordx4 v2, s[32:35], s48 offen offset:0 sc1 lds
  buffer_load_dwordx4 v2, s[32:35], s48 offen offset:1024 sc1 lds
  s_mov_b32 s65, s47
  s_mov_b32 s66, s58
  s_add_u32 m0, s65, 0
  s_add_u32 s68, s66, 0
  buffer_load_dwordx4 v2, s[32:35], s68 offen offset:0 sc1 lds
  buffer_load_dwordx4 v2, s[32:35], s68 offen offset:1024 sc1 lds
  buffer_load_dwordx4 v2, s[32:35], s68 offen offset:2048 sc1 lds
  buffer_load_dwordx4 v2, s[32:35], s68 offen offset:3072 sc1 lds
  s_add_u32 m0, s65, 4096
  s_add_u32 s68, s66, 4096
  buffer_load_dwordx4 v2, s[32:35], s68 offen offset:0 sc1 lds
  buffer_load_dwordx4 v2, s[32:35], s68 offen offset:1024 sc1 lds
  buffer_load_dwordx4 v2, s[32:35], s68 offen offset:2048 sc1 lds
  buffer_load_dwordx4 v2, s[32:35], s68 offen offset:3072 sc1 lds
  s_add_u32 m0, s65, 8192
  s_add_u32 s68, s66, 8192
  buffer_load_dwordx4 v2, s[32:35], s68 offen offset:0 sc1 lds
  buffer_load_dwordx4 v2, s[32:35], s68 offen offset:1024 sc1 lds
  s_lshl_b32 s67, s44, 4
  s_add_u32 s67, s67, s45
  s_lshl_b32 s67, s67, 7
  s_add_u32 s67, s67, 16842752
  s_and_b32 s46, s2, 7
  s_lshr_b32 s47, s2, 3
  s_and_b32 s56, s47, 3
  s_lshl_b32 s48, s46, 2
  s_add_u32 s56, s56, s48
  s_lshr_b32 s57, s47, 2
  s_and_b32 s54, s26, 3
  s_lshr_b32 s55, s26, 2
  s_lshl_b32 s58, s57, 3
  s_lshl_b32 s48, s54, 1
  s_add_u32 s58, s58, s48
  s_lshl_b32 s44, s46, 3
  s_and_b32 s48, s47, 7
  s_add_u32 s44, s44, s48
  s_lshr_b32 s45, s47, 3
  s_lshl_b32 s52, s45, 2
  s_add_u32 s52, s52, s54
  s_mul_i32 s48, s55, 43
  s_add_u32 s48, s48, 32
  s_mul_i32 s49, s52, 118
  s_add_u32 s49, s49, s48
  s_lshl_b32 s49, s49, 10
  s_add_u32 s49, s49, 65536
  s_add_u32 s36, s24, s49
  s_addc_u32 s37, s25, 0
  s_and_b32 s37, s37, 0xffff
  s_mov_b32 s38, 44032
  s_mov_b32 s39, 0x20000
  s_mul_i32 s49, s44, 118
  s_add_u32 s49, s49, s48
  s_lshl_b32 s49, s49, 10
  s_add_u32 s49, s49, 8388608
  s_add_u32 s40, s24, s49
  s_addc_u32 s41, s25, 0
  s_and_b32 s41, s41, 0xffff
  s_mov_b32 s42, 44032
  s_mov_b32 s43, 0x20000
  v_lshlrev_b32 v2, 4, v1
  v_lshrrev_b32 v8, 5, v1
  v_bfe_u32 v9, v1, 2, 2
  v_lshl_add_u32 v9, v8, 2, v9
  v_lshlrev_b32 v9, 5, v9
  v_and_b32 v10, 3, v1
  v_lshl_add_u32 v9, v10, 3, v9
  v_add_u32 v9, 65536, v9
  v_xor_b32 v10, 1, v8
  v_lshlrev_b32 v10, 7, v10
  v_and_b32 v11, 15, v1
  v_lshl_add_u32 v10, v11, 3, v10
  v_add_u32 v10, 131072, v10
  v_bfe_u32 v11, v1, 4, 1
  v_cmp_eq_u32 s[70:71], 1, v11
  v_mov_b32 v15, 2048
  v_mov_b32 v16, 0
  v_cndmask_b32 v14, v9, v10, s[70:71]
  v_cndmask_b32 v7, v15, v16, s[70:71]
  v_mov_b32 v168, 0
  v_mov_b32 v169, 0
  v_mov_b32 v170, 0
  v_mov_b32 v171, 0
  v_mov_b32 v172, 0
  v_mov_b32 v173, 0
  v_mov_b32 v174, 0
  v_mov_b32 v175, 0
  v_mov_b32 v176, 0
  v_mov_b32 v177, 0
  v_mov_b32 v178, 0
  v_mov_b32 v179, 0
  v_mov_b32 v180, 0
  v_mov_b32 v181, 0
  v_mov_b32 v182, 0
  v_mov_b32 v183, 0
  v_mov_b32 v184, 0
  v_mov_b32 v185, 0
  v_mov_b32 v186, 0
  v_mov_b32 v187, 0
  v_mov_b32 v188, 0
  v_mov_b32 v189, 0
  v_mov_b32 v190, 0
  v_mov_b32 v191, 0
  v_mov_b32 v192, 0
  v_mov_b32 v193, 0
  v_mov_b32 v194, 0
  v_mov_b32 v195, 0
  v_mov_b32 v196, 0
  v_mov_b32 v197, 0
  v_mov_b32 v198, 0
  v_mov_b32 v199, 0
  v_mov_b32 v200, 0
  v_mov_b32 v201, 0
  v_mov_b32 v202, 0
  v_mov_b32 v203, 0
  v_mov_b32 v204, 0
  v_mov_b32 v205, 0
  v_mov_b32 v206, 0
  v_mov_b32 v207, 0
  v_mov_b32 v208, 0
  v_mov_b32 v209, 0
  v_mov_b32 v210, 0
  v_mov_b32 v211, 0
  v_mov_b32 v212, 0
  v_mov_b32 v213, 0
  v_mov_b32 v214, 0
  v_mov_b32 v215, 0
  s_mov_b32 s50, 0
  s_lshl_b32 s51, s55, 5
  s_mov_b32 s53, 4
  s_mov_b32 s59, 0
  v_mov_b32 v96, 0
  v_mov_b32 v112, 0
  v_mov_b32 v97, 0
  v_mov_b32 v113, 0
  v_mov_b32 v98, 0
  v_mov_b32 v114, 0
  v_mov_b32 v99, 0
  v_mov_b32 v115, 0
  v_mov_b32 v100, 0
  v_mov_b32 v116, 0
  v_mov_b32 v101, 0
  v_mov_b32 v117, 0
  v_mov_b32 v102, 0
  v_mov_b32 v118, 0
  v_mov_b32 v103, 0
  v_mov_b32 v119, 0
  v_mov_b32 v104, 0
  v_mov_b32 v120, 0
  v_mov_b32 v105, 0
  v_mov_b32 v121, 0
  v_mov_b32 v106, 0
  v_mov_b32 v122, 0
  v_mov_b32 v107, 0
  v_mov_b32 v123, 0
  v_mov_b32 v108, 0
  v_mov_b32 v124, 0
  v_mov_b32 v109, 0
  v_mov_b32 v125, 0
  v_mov_b32 v110, 0
  v_mov_b32 v126, 0
  v_mov_b32 v111, 0
  v_mov_b32 v127, 0
  v_mov_b32 v128, 0
  v_mov_b32 v160, 0
  v_mov_b32 v129, 0
  v_mov_b32 v161, 0
  v_mov_b32 v130, 0
  v_mov_b32 v162, 0
  v_mov_b32 v131, 0
  v_mov_b32 v163, 0
  v_mov_b32 v132, 0
  v_mov_b32 v164, 0
  v_mov_b32 v133, 0
  v_mov_b32 v165, 0
  v_mov_b32 v134, 0
  v_mov_b32 v166, 0
  v_mov_b32 v135, 0
  v_mov_b32 v167, 0
  s_waitcnt vmcnt(0) lgkmcnt(0)
  s_barrier
  s_add_u32 m0, s65, 10240
  s_add_u32 s68, s66, 10240
  buffer_load_dwordx4 v2, s[32:35], s68 offen offset:0 sc1 lds
  buffer_load_dwordx4 v2, s[32:35], s68 offen offset:1024 sc1 lds
  buffer_load_dwordx4 v2, s[32:35], s68 offen offset:2048 sc1 lds
  buffer_load_dwordx4 v2, s[32:35], s68 offen offset:3072 sc1 lds
  s_add_u32 m0, s65, 14336
  s_add_u32 s68, s66, 14336
  buffer_load_dwordx4 v2, s[32:35], s68 offen offset:0 sc1 lds
  buffer_load_dwordx4 v2, s[32:35], s68 offen offset:1024 sc1 lds
  buffer_load_dwordx4 v2, s[32:35], s68 offen offset:2048 sc1 lds
  buffer_load_dwordx4 v2, s[32:35], s68 offen offset:3072 sc1 lds
  s_add_u32 m0, s65, 18432
  s_add_u32 s68, s66, 18432
  buffer_load_dwordx4 v2, s[32:35], s68 offen offset:0 sc1 lds
  buffer_load_dwordx4 v2, s[32:35], s68 offen offset:1024 sc1 lds
  buffer_load_dwordx4 v2, s[32:35], s68 offen offset:2048 sc1 lds
  buffer_load_dwordx4 v2, s[32:35], s68 offen offset:3072 sc1 lds
  s_add_u32 m0, s65, 22528
  s_add_u32 s68, s66, 22528
  buffer_load_dwordx4 v2, s[32:35], s68 offen offset:0 sc1 lds
  buffer_load_dwordx4 v2, s[32:35], s68 offen offset:1024 sc1 lds
  buffer_load_dwordx4 v2, s[32:35], s68 offen offset:2048 sc1 lds
  buffer_load_dwordx4 v2, s[32:35], s68 offen offset:3072 sc1 lds
  s_add_u32 m0, s65, 26624
  s_add_u32 s68, s66, 26624
  buffer_load_dwordx4 v2, s[32:35], s68 offen offset:0 sc1 lds
  buffer_load_dwordx4 v2, s[32:35], s68 offen offset:1024 sc1 lds
  buffer_load_dwordx4 v2, s[32:35], s68 offen offset:2048 sc1 lds
  buffer_load_dwordx4 v2, s[32:35], s68 offen offset:3072 sc1 lds
  s_add_u32 m0, s65, 30720
  s_add_u32 s68, s66, 30720
  buffer_load_dwordx4 v2, s[32:35], s68 offen offset:0 sc1 lds
  buffer_load_dwordx4 v2, s[32:35], s68 offen offset:1024 sc1 lds
L_attn:
  s_lshl_b32 s48, s54, 11
  s_add_u32 s48, s48, 151552
  v_add_u32 v4, s48, v2
  ds_read_b128 v[136:139], v4
  ds_read_b128 v[140:143], v4 offset:1024
  ds_read_b128 v[16:19], v2
  s_lshl_b32 s46, s51, 10
  v_add_u32 v12, s46, v2
  v_mov_b32 v10, s46
  v_mov_b32 v11, 0
  v_cndmask_b32 v10, v10, v11, s[70:71]
  v_add_u32 v3, v14, v10
  ds_read_b128 v[144:147], v12
  ds_read_b128 v[148:151], v12 offset:1024
  ds_read_b64_tr_b16 v[152:153], v3 offset:0
  ds_read_b64_tr_b16 v[154:155], v3 offset:256
  ds_read_b64_tr_b16 v[156:157], v3 offset:512
  ds_read_b64_tr_b16 v[158:159], v3 offset:768
  s_waitcnt lgkmcnt(6)
  v_mfma_f32_32x32x16_bf16 v[32:47], v[16:19], v[136:139], 0
  v_mfma_f32_32x32x16_bf16 v[48:63], v[16:19], v[140:143], 0
  s_nop 10
  v_max3_f32 v8, v32, v33, v34
  v_max3_f32 v8, v8, v35, v36
  v_max3_f32 v8, v8, v37, v38
  v_max3_f32 v8, v8, v39, v40
  v_max3_f32 v8, v8, v41, v42
  v_max3_f32 v8, v8, v43, v44
  v_max3_f32 v8, v8, v45, v46
  v_max_f32 v8, v8, v47
  v_max3_f32 v9, v48, v49, v50
  v_max3_f32 v9, v9, v51, v52
  v_max3_f32 v9, v9, v53, v54
  v_max3_f32 v9, v9, v55, v56
  v_max3_f32 v9, v9, v57, v58
  v_max3_f32 v9, v9, v59, v60
  v_max3_f32 v9, v9, v61, v62
  v_max_f32 v9, v9, v63
  v_mov_b32 v10, v8
  v_mov_b32 v11, v9
  s_nop 1
  v_permlane32_swap_b32 v8, v10
  v_permlane32_swap_b32 v9, v11
  s_nop 1
  v_max_f32 v8, v8, v10
  v_max_f32 v9, v9, v11
  v_sub_f32 v64, 0, v8
  v_sub_f32 v80, 0, v9
  v_sub_f32 v65, 0, v8
  v_sub_f32 v81, 0, v9
  v_sub_f32 v66, 0, v8
  v_sub_f32 v82, 0, v9
  v_sub_f32 v67, 0, v8
  v_sub_f32 v83, 0, v9
  v_sub_f32 v68, 0, v8
  v_sub_f32 v84, 0, v9
  v_sub_f32 v69, 0, v8
  v_sub_f32 v85, 0, v9
  v_sub_f32 v70, 0, v8
  v_sub_f32 v86, 0, v9
  v_sub_f32 v71, 0, v8
  v_sub_f32 v87, 0, v9
  v_sub_f32 v72, 0, v8
  v_sub_f32 v88, 0, v9
  v_sub_f32 v73, 0, v8
  v_sub_f32 v89, 0, v9
  v_sub_f32 v74, 0, v8
  v_sub_f32 v90, 0, v9
  v_sub_f32 v75, 0, v8
  v_sub_f32 v91, 0, v9
  v_sub_f32 v76, 0, v8
  v_sub_f32 v92, 0, v9
  v_sub_f32 v77, 0, v8
  v_sub_f32 v93, 0, v9
  v_sub_f32 v78, 0, v8
  v_sub_f32 v94, 0, v9
  v_sub_f32 v79, 0, v8
  v_sub_f32 v95, 0, v9
  s_branch L_go
L_setm:
  v_mov_b32 v10, v8
  v_mov_b32 v11, v9
  s_nop 1
  v_permlane32_swap_b32 v8, v10
  v_permlane32_swap_b32 v9, v11
  s_nop 1
  v_max_f32 v8, v8, v10
  v_max_f32 v9, v9, v11
  v_sub_f32 v64, 0, v8
  v_sub_f32 v80, 0, v9
  v_sub_f32 v65, 0, v8
  v_sub_f32 v81, 0, v9
  v_sub_f32 v66, 0, v8
  v_sub_f32 v82, 0, v9
  v_sub_f32 v67, 0, v8
  v_sub_f32 v83, 0, v9
  v_sub_f32 v68, 0, v8
  v_sub_f32 v84, 0, v9
  v_sub_f32 v69, 0, v8
  v_sub_f32 v85, 0, v9
  v_sub_f32 v70, 0, v8
  v_sub_f32 v86, 0, v9
  v_sub_f32 v71, 0, v8
  v_sub_f32 v87, 0, v9
  v_sub_f32 v72, 0, v8
  v_sub_f32 v88, 0, v9
  v_sub_f32 v73, 0, v8
  v_sub_f32 v89, 0, v9
  v_sub_f32 v74, 0, v8
  v_sub_f32 v90, 0, v9
  v_sub_f32 v75, 0, v8
  v_sub_f32 v91, 0, v9
  v_sub_f32 v76, 0, v8
  v_sub_f32 v92, 0, v9
  v_sub_f32 v77, 0, v8
  v_sub_f32 v93, 0, v9
  v_sub_f32 v78, 0, v8
  v_sub_f32 v94, 0, v9
  v_sub_f32 v79, 0, v8
  v_sub_f32 v95, 0, v9
  v_mov_b32 v96, 0
  v_mov_b32 v112, 0
  v_mov_b32 v97, 0
  v_mov_b32 v113, 0
  v_mov_b32 v98, 0
  v_mov_b32 v114, 0
  v_mov_b32 v99, 0
  v_mov_b32 v115, 0
  v_mov_b32 v100, 0
  v_mov_b32 v116, 0
  v_mov_b32 v101, 0
  v_mov_b32 v117, 0
  v_mov_b32 v102, 0
  v_mov_b32 v118, 0
  v_mov_b32 v103, 0
  v_mov_b32 v119, 0
  v_mov_b32 v104, 0
  v_mov_b32 v120, 0
  v_mov_b32 v105, 0
  v_mov_b32 v121, 0
  v_mov_b32 v106, 0
  v_mov_b32 v122, 0
  v_mov_b32 v107, 0
  v_mov_b32 v123, 0
  v_mov_b32 v108, 0
  v_mov_b32 v124, 0
  v_mov_b32 v109, 0
  v_mov_b32 v125, 0
  v_mov_b32 v110, 0
  v_mov_b32 v126, 0
  v_mov_b32 v111, 0
  v_mov_b32 v127, 0
  v_mov_b32 v128, 0
  v_mov_b32 v160, 0
  v_mov_b32 v129, 0
  v_mov_b32 v161, 0
  v_mov_b32 v130, 0
  v_mov_b32 v162, 0
  v_mov_b32 v131, 0
  v_mov_b32 v163, 0
  v_mov_b32 v132, 0
  v_mov_b32 v164, 0
  v_mov_b32 v133, 0
  v_mov_b32 v165, 0
  v_mov_b32 v134, 0
  v_mov_b32 v166, 0
  v_mov_b32 v135, 0
  v_mov_b32 v167, 0
  s_lshl_b32 s46, s51, 10
  v_add_u32 v12, s46, v2
  v_mov_b32 v10, s46
  v_mov_b32 v11, 0
  v_cndmask_b32 v10, v10, v11, s[70:71]
  v_add_u32 v3, v14, v10
  ds_read_b128 v[144:147], v12
  ds_read_b128 v[148:151], v12 offset:1024
  ds_read_b64_tr_b16 v[152:153], v3 offset:0
  ds_read_b64_tr_b16 v[154:155], v3 offset:256
  ds_read_b64_tr_b16 v[156:157], v3 offset:512
  ds_read_b64_tr_b16 v[158:159], v3 offset:768
L_go:
  s_waitcnt lgkmcnt(0)
  v_mfma_f32_32x32x16_bf16 v[32:47], v[144:147], v[136:139], v[64:79]
  s_mov_b32 s60, 0
  s_nop 9
  s_cmp_eq_u32 s55, 1
  s_cbranch_scc0 L_pr1_41
  s_setprio 1
L_pr1_41:
  v_mov_b32 v4, 160196
  s_cmp_eq_u32 s26, 6
  s_cbranch_scc0 L_fhq_42
  s_mov_b32 s46, 0
L_fhps_43:
  ds_read_b32 v5, v4
  s_waitcnt lgkmcnt(0)
  v_readfirstlane_b32 s47, v5
  s_add_u32 s46, s46, 1
  s_cmp_ge_u32 s46, 2097152
  s_cbranch_scc1 L_fhpg_44
  s_cmp_lt_u32 s47, 4
  s_cbranch_scc1 L_fhps_43
L_fhpg_44:
  v_mov_b32 v28, s27
  v_mov_b32 v29, 0
  s_mov_b64 exec, 1
  buffer_store_dword v28, v29, s[32:35], s67 offen sc1
  s_mov_b64 exec, -1
  s_nop 0
L_fhq_42:
.p2align 6
L_body0:
  s_cmp_eq_u32 s55, 0
  s_cbranch_scc0 L_pr_45
  s_setprio 2
L_pr_45:
  v_mfma_f32_32x32x16_bf16 v[48:63], v[144:147], v[140:143], v[80:95]
  v_exp_f32 v32, v32
  v_exp_f32 v33, v33
  v_mfma_f32_32x32x16_bf16 v[112:127], v[164:167], v[132:135], v[112:127]
  ds_read_b128 v[144:147], v12 offset:2048
  v_exp_f32 v34, v34
  v_exp_f32 v35, v35
  v_exp_f32 v36, v36
  v_exp_f32 v37, v37
  v_exp_f32 v38, v38
  v_exp_f32 v39, v39
  v_cvt_pk_bf16_f32 v128, v32, v33
  v_cvt_pk_bf16_f32 v129, v34, v35
  v_cvt_pk_bf16_f32 v130, v36, v37
  v_cvt_pk_bf16_f32 v131, v38, v39
  ds_read_b64_tr_b16 v[160:161], v3 offset:1024
  ds_read_b64_tr_b16 v[162:163], v3 offset:1280
  ds_read_b64_tr_b16 v[164:165], v3 offset:1536
  ds_read_b64_tr_b16 v[166:167], v3 offset:1792
  v_exp_f32 v40, v40
  v_exp_f32 v41, v41
  v_mfma_f32_32x32x16_bf16 v[96:111], v[152:155], v[128:131], v[96:111]
  v_exp_f32 v42, v42
  v_exp_f32 v43, v43
  v_exp_f32 v44, v44
  v_exp_f32 v45, v45
  v_exp_f32 v46, v46
  v_exp_f32 v47, v47
  v_cvt_pk_bf16_f32 v132, v40, v41
  v_cvt_pk_bf16_f32 v133, v42, v43
  v_cvt_pk_bf16_f32 v134, v44, v45
  v_cvt_pk_bf16_f32 v135, v46, v47
  s_waitcnt lgkmcnt(0)
  v_mfma_f32_32x32x16_bf16 v[32:47], v[148:151], v[136:139], v[64:79]
  v_exp_f32 v48, v48
  v_exp_f32 v49, v49
  v_mfma_f32_32x32x16_bf16 v[96:111], v[156:159], v[132:135], v[96:111]
  v_exp_f32 v50, v50
  v_exp_f32 v51, v51
  v_exp_f32 v52, v52
  v_exp_f32 v53, v53
  v_exp_f32 v54, v54
  v_exp_f32 v55, v55
  v_cvt_pk_bf16_f32 v128, v48, v49
  v_cvt_pk_bf16_f32 v129, v50, v51
  v_cvt_pk_bf16_f32 v130, v52, v53
  v_cvt_pk_bf16_f32 v131, v54, v55
  v_exp_f32 v56, v56
  v_exp_f32 v57, v57
  v_mfma_f32_32x32x16_bf16 v[112:127], v[152:155], v[128:131], v[112:127]
  v_exp_f32 v58, v58
  v_exp_f32 v59, v59
  v_exp_f32 v60, v60
  v_exp_f32 v61, v61
  v_exp_f32 v62, v62
  v_exp_f32 v63, v63
  v_cvt_pk_bf16_f32 v132, v56, v57
  v_cvt_pk_bf16_f32 v133, v58, v59
  v_cvt_pk_bf16_f32 v134, v60, v61
  v_cvt_pk_bf16_f32 v135, v62, v63
  v_mfma_f32_32x32x16_bf16 v[48:63], v[148:151], v[140:143], v[80:95]
  v_exp_f32 v32, v32
  v_exp_f32 v33, v33
  v_mfma_f32_32x32x16_bf16 v[112:127], v[156:159], v[132:135], v[112:127]
  ds_read_b128 v[148:151], v12 offset:3072
  v_exp_f32 v34, v34
  v_exp_f32 v35, v35
  v_exp_f32 v36, v36
  v_exp_f32 v37, v37
  v_exp_f32 v38, v38
  v_exp_f32 v39, v39
  v_cvt_pk_bf16_f32 v128, v32, v33
  v_cvt_pk_bf16_f32 v129, v34, v35
  v_cvt_pk_bf16_f32 v130, v36, v37
  v_cvt_pk_bf16_f32 v131, v38, v39
  ds_read_b64_tr_b16 v[152:153], v3 offset:2048
  ds_read_b64_tr_b16 v[154:155], v3 offset:2304
  ds_read_b64_tr_b16 v[156:157], v3 offset:2560
  ds_read_b64_tr_b16 v[158:159], v3 offset:2816
  v_exp_f32 v40, v40
  v_exp_f32 v41, v41
  v_mfma_f32_32x32x16_bf16 v[96:111], v[160:163], v[128:131], v[96:111]
  v_exp_f32 v42, v42
  v_exp_f32 v43, v43
  v_exp_f32 v44, v44
  v_exp_f32 v45, v45
  v_exp_f32 v46, v46
  v_exp_f32 v47, v47
  v_cvt_pk_bf16_f32 v132, v40, v41
  v_cvt_pk_bf16_f32 v133, v42, v43
  v_cvt_pk_bf16_f32 v134, v44, v45
  v_cvt_pk_bf16_f32 v135, v46, v47
  s_waitcnt lgkmcnt(0)
  v_mfma_f32_32x32x16_bf16 v[32:47], v[144:147], v[136:139], v[64:79]
  v_exp_f32 v48, v48
  v_exp_f32 v49, v49
  v_mfma_f32_32x32x16_bf16 v[96:111], v[164:167], v[132:135], v[96:111]
  v_exp_f32 v50, v50
  v_exp_f32 v51, v51
  v_exp_f32 v52, v52
  v_exp_f32 v53, v53
  v_exp_f32 v54, v54
  v_exp_f32 v55, v55
  v_cvt_pk_bf16_f32 v128, v48, v49
  v_cvt_pk_bf16_f32 v129, v50, v51
  v_cvt_pk_bf16_f32 v130, v52, v53
  v_cvt_pk_bf16_f32 v131, v54, v55
  v_exp_f32 v56, v56
  v_exp_f32 v57, v57
  v_mfma_f32_32x32x16_bf16 v[112:127], v[160:163], v[128:131], v[112:127]
  v_exp_f32 v58, v58
  v_exp_f32 v59, v59
  v_exp_f32 v60, v60
  v_exp_f32 v61, v61
  v_exp_f32 v62, v62
  v_exp_f32 v63, v63
  v_add_u32 v12, 2048, v12
  v_add_u32 v3, v7, v3
  v_cvt_pk_bf16_f32 v132, v56, v57
  v_cvt_pk_bf16_f32 v133, v58, v59
  v_cvt_pk_bf16_f32 v134, v60, v61
  v_cvt_pk_bf16_f32 v135, v62, v63
  s_or_b32 s46, s50, s60
  s_cmp_lg_u32 s46, 0
  s_cbranch_scc1 L_fhp_46
  s_cmp_eq_u32 s55, 0
  s_cbranch_scc0 L_fhp_46
  v_mov_b32 v4, 160196
  s_waitcnt vmcnt(0)
  v_mov_b32 v5, 1
  s_mov_b64 exec, 1
  ds_add_u32 v4, v5
  s_mov_b64 exec, -1
  s_nop 0
L_fhp_46:
  v_mfma_f32_32x32x16_bf16 v[48:63], v[144:147], v[140:143], v[80:95]
  v_exp_f32 v32, v32
  v_exp_f32 v33, v33
  v_mfma_f32_32x32x16_bf16 v[112:127], v[164:167], v[132:135], v[112:127]
  ds_read_b128 v[144:147], v12 offset:2048
  v_exp_f32 v34, v34
  v_exp_f32 v35, v35
  v_exp_f32 v36, v36
  v_exp_f32 v37, v37
  v_exp_f32 v38, v38
  v_exp_f32 v39, v39
  v_cvt_pk_bf16_f32 v128, v32, v33
  v_cvt_pk_bf16_f32 v129, v34, v35
  v_cvt_pk_bf16_f32 v130, v36, v37
  v_cvt_pk_bf16_f32 v131, v38, v39
  ds_read_b64_tr_b16 v[160:161], v3 offset:1024
  ds_read_b64_tr_b16 v[162:163], v3 offset:1280
  ds_read_b64_tr_b16 v[164:165], v3 offset:1536
  ds_read_b64_tr_b16 v[166:167], v3 offset:1792
  v_exp_f32 v40, v40
  v_exp_f32 v41, v41
  v_mfma_f32_32x32x16_bf16 v[96:111], v[152:155], v[128:131], v[96:111]
  v_exp_f32 v42, v42
  v_exp_f32 v43, v43
  v_exp_f32 v44, v44
  v_exp_f32 v45, v45
  v_exp_f32 v46, v46
  v_exp_f32 v47, v47
  v_cvt_pk_bf16_f32 v132, v40, v41
  v_cvt_pk_bf16_f32 v133, v42, v43
  v_cvt_pk_bf16_f32 v134, v44, v45
  v_cvt_pk_bf16_f32 v135, v46, v47
  s_waitcnt lgkmcnt(0)
  v_mfma_f32_32x32x16_bf16 v[32:47], v[148:151], v[136:139], v[64:79]
  v_exp_f32 v48, v48
  v_exp_f32 v49, v49
  v_mfma_f32_32x32x16_bf16 v[96:111], v[156:159], v[132:135], v[96:111]
  v_exp_f32 v50, v50
  v_exp_f32 v51, v51
  v_exp_f32 v52, v52
  v_exp_f32 v53, v53
  v_exp_f32 v54, v54
  v_exp_f32 v55, v55
  v_cvt_pk_bf16_f32 v128, v48, v49
  v_cvt_pk_bf16_f32 v129, v50, v51
  v_cvt_pk_bf16_f32 v130, v52, v53
  v_cvt_pk_bf16_f32 v131, v54, v55
  v_exp_f32 v56, v56
  v_exp_f32 v57, v57
  v_mfma_f32_32x32x16_bf16 v[112:127], v[152:155], v[128:131], v[112:127]
  v_exp_f32 v58, v58
  v_exp_f32 v59, v59
  v_exp_f32 v60, v60
  v_exp_f32 v61, v61
  v_exp_f32 v62, v62
  v_exp_f32 v63, v63
  v_cvt_pk_bf16_f32 v132, v56, v57
  v_cvt_pk_bf16_f32 v133, v58, v59
  v_cvt_pk_bf16_f32 v134, v60, v61
  v_cvt_pk_bf16_f32 v135, v62, v63
  v_mfma_f32_32x32x16_bf16 v[48:63], v[148:151], v[140:143], v[80:95]
  v_exp_f32 v32, v32
  v_exp_f32 v33, v33
  v_mfma_f32_32x32x16_bf16 v[112:127], v[156:159], v[132:135], v[112:127]
  ds_read_b128 v[148:151], v12 offset:3072
  v_exp_f32 v34, v34
  v_exp_f32 v35, v35
  v_exp_f32 v36, v36
  v_exp_f32 v37, v37
  v_exp_f32 v38, v38
  v_exp_f32 v39, v39
  v_cvt_pk_bf16_f32 v128, v32, v33
  v_cvt_pk_bf16_f32 v129, v34, v35
  v_cvt_pk_bf16_f32 v130, v36, v37
  v_cvt_pk_bf16_f32 v131, v38, v39
  ds_read_b64_tr_b16 v[152:153], v3 offset:2048
  ds_read_b64_tr_b16 v[154:155], v3 offset:2304
  ds_read_b64_tr_b16 v[156:157], v3 offset:2560
  ds_read_b64_tr_b16 v[158:159], v3 offset:2816
  v_exp_f32 v40, v40
  v_exp_f32 v41, v41
  v_mfma_f32_32x32x16_bf16 v[96:111], v[160:163], v[128:131], v[96:111]
  v_exp_f32 v42, v42
  v_exp_f32 v43, v43
  v_exp_f32 v44, v44
  v_exp_f32 v45, v45
  v_exp_f32 v46, v46
  v_exp_f32 v47, v47
  v_cvt_pk_bf16_f32 v132, v40, v41
  v_cvt_pk_bf16_f32 v133, v42, v43
  v_cvt_pk_bf16_f32 v134, v44, v45
  v_cvt_pk_bf16_f32 v135, v46, v47
  s_waitcnt lgkmcnt(0)
  v_mfma_f32_32x32x16_bf16 v[32:47], v[144:147], v[136:139], v[64:79]
  v_exp_f32 v48, v48
  v_exp_f32 v49, v49
  v_mfma_f32_32x32x16_bf16 v[96:111], v[164:167], v[132:135], v[96:111]
  v_exp_f32 v50, v50
  v_exp_f32 v51, v51
  v_exp_f32 v52, v52
  v_exp_f32 v53, v53
  v_exp_f32 v54, v54
  v_exp_f32 v55, v55
  v_cvt_pk_bf16_f32 v128, v48, v49
  v_cvt_pk_bf16_f32 v129, v50, v51
  v_cvt_pk_bf16_f32 v130, v52, v53
  v_cvt_pk_bf16_f32 v131, v54, v55
  v_exp_f32 v56, v56
  v_exp_f32 v57, v57
  v_mfma_f32_32x32x16_bf16 v[112:127], v[160:163], v[128:131], v[112:127]
  v_exp_f32 v58, v58
  v_exp_f32 v59, v59
  v_exp_f32 v60, v60
  v_exp_f32 v61, v61
  v_exp_f32 v62, v62
  v_exp_f32 v63, v63
  v_add_u32 v12, 2048, v12
  v_add_u32 v3, v7, v3
  v_cvt_pk_bf16_f32 v132, v56, v57
  v_cvt_pk_bf16_f32 v133, v58, v59
  v_cvt_pk_bf16_f32 v134, v60, v61
  v_cvt_pk_bf16_f32 v135, v62, v63
  v_mfma_f32_32x32x16_bf16 v[48:63], v[144:147], v[140:143], v[80:95]
  v_exp_f32 v32, v32
  v_exp_f32 v33, v33
  v_mfma_f32_32x32x16_bf16 v[112:127], v[164:167], v[132:135], v[112:127]
  ds_read_b128 v[144:147], v12 offset:2048
  v_exp_f32 v34, v34
  v_exp_f32 v35, v35
  v_exp_f32 v36, v36
  v_exp_f32 v37, v37
  v_exp_f32 v38, v38
  v_exp_f32 v39, v39
  v_cvt_pk_bf16_f32 v128, v32, v33
  v_cvt_pk_bf16_f32 v129, v34, v35
  v_cvt_pk_bf16_f32 v130, v36, v37
  v_cvt_pk_bf16_f32 v131, v38, v39
  ds_read_b64_tr_b16 v[160:161], v3 offset:1024
  ds_read_b64_tr_b16 v[162:163], v3 offset:1280
  ds_read_b64_tr_b16 v[164:165], v3 offset:1536
  ds_read_b64_tr_b16 v[166:167], v3 offset:1792
  v_exp_f32 v40, v40
  v_exp_f32 v41, v41
  v_mfma_f32_32x32x16_bf16 v[96:111], v[152:155], v[128:131], v[96:111]
  v_exp_f32 v42, v42
  v_exp_f32 v43, v43
  v_exp_f32 v44, v44
  v_exp_f32 v45, v45
  v_exp_f32 v46, v46
  v_exp_f32 v47, v47
  v_cvt_pk_bf16_f32 v132, v40, v41
  v_cvt_pk_bf16_f32 v133, v42, v43
  v_cvt_pk_bf16_f32 v134, v44, v45
  v_cvt_pk_bf16_f32 v135, v46, v47
  s_waitcnt lgkmcnt(0)
  v_mfma_f32_32x32x16_bf16 v[32:47], v[148:151], v[136:139], v[64:79]
  v_exp_f32 v48, v48
  v_exp_f32 v49, v49
  v_mfma_f32_32x32x16_bf16 v[96:111], v[156:159], v[132:135], v[96:111]
  v_exp_f32 v50, v50
  v_exp_f32 v51, v51
  v_exp_f32 v52, v52
  v_exp_f32 v53, v53
  v_exp_f32 v54, v54
  v_exp_f32 v55, v55
  v_cvt_pk_bf16_f32 v128, v48, v49
  v_cvt_pk_bf16_f32 v129, v50, v51
  v_cvt_pk_bf16_f32 v130, v52, v53
  v_cvt_pk_bf16_f32 v131, v54, v55
  v_exp_f32 v56, v56
  v_exp_f32 v57, v57
  v_mfma_f32_32x32x16_bf16 v[112:127], v[152:155], v[128:131], v[112:127]
  v_exp_f32 v58, v58
  v_exp_f32 v59, v59
  v_exp_f32 v60, v60
  v_exp_f32 v61, v61
  v_exp_f32 v62, v62
  v_exp_f32 v63, v63
  v_cvt_pk_bf16_f32 v132, v56, v57
  v_cvt_pk_bf16_f32 v133, v58, v59
  v_cvt_pk_bf16_f32 v134, v60, v61
  v_cvt_pk_bf16_f32 v135, v62, v63
  v_mfma_f32_32x32x16_bf16 v[48:63], v[148:151], v[140:143], v[80:95]
  v_exp_f32 v32, v32
  v_exp_f32 v33, v33
  v_mfma_f32_32x32x16_bf16 v[112:127], v[156:159], v[132:135], v[112:127]
  ds_read_b128 v[148:151], v12 offset:3072
  v_exp_f32 v34, v34
  v_exp_f32 v35, v35
  v_exp_f32 v36, v36
  v_exp_f32 v37, v37
  v_exp_f32 v38, v38
  v_exp_f32 v39, v39
  v_cvt_pk_bf16_f32 v128, v32, v33
  v_cvt_pk_bf16_f32 v129, v34, v35
  v_cvt_pk_bf16_f32 v130, v36, v37
  v_cvt_pk_bf16_f32 v131, v38, v39
  ds_read_b64_tr_b16 v[152:153], v3 offset:2048
  ds_read_b64_tr_b16 v[154:155], v3 offset:2304
  ds_read_b64_tr_b16 v[156:157], v3 offset:2560
  ds_read_b64_tr_b16 v[158:159], v3 offset:2816
  v_exp_f32 v40, v40
  v_exp_f32 v41, v41
  v_mfma_f32_32x32x16_bf16 v[96:111], v[160:163], v[128:131], v[96:111]
  v_exp_f32 v42, v42
  v_exp_f32 v43, v43
  v_exp_f32 v44, v44
  v_exp_f32 v45, v45
  v_exp_f32 v46, v46
  v_exp_f32 v47, v47
  v_cvt_pk_bf16_f32 v132, v40, v41
  v_cvt_pk_bf16_f32 v133, v42, v43
  v_cvt_pk_bf16_f32 v134, v44, v45
  v_cvt_pk_bf16_f32 v135, v46, v47
  s_waitcnt lgkmcnt(0)
  v_mfma_f32_32x32x16_bf16 v[32:47], v[144:147], v[136:139], v[64:79]
  v_exp_f32 v48, v48
  v_exp_f32 v49, v49
  v_mfma_f32_32x32x16_bf16 v[96:111], v[164:167], v[132:135], v[96:111]
  v_exp_f32 v50, v50
  v_exp_f32 v51, v51
  v_exp_f32 v52, v52
  v_exp_f32 v53, v53
  v_exp_f32 v54, v54
  v_exp_f32 v55, v55
  v_cvt_pk_bf16_f32 v128, v48, v49
  v_cvt_pk_bf16_f32 v129, v50, v51
  v_cvt_pk_bf16_f32 v130, v52, v53
  v_cvt_pk_bf16_f32 v131, v54, v55
  v_exp_f32 v56, v56
  v_exp_f32 v57, v57
  v_mfma_f32_32x32x16_bf16 v[112:127], v[160:163], v[128:131], v[112:127]
  v_exp_f32 v58, v58
  v_exp_f32 v59, v59
  v_exp_f32 v60, v60
  v_exp_f32 v61, v61
  v_exp_f32 v62, v62
  v_exp_f32 v63, v63
  v_add_u32 v12, 2048, v12
  v_add_u32 v3, v7, v3
  v_cvt_pk_bf16_f32 v132, v56, v57
  v_cvt_pk_bf16_f32 v133, v58, v59
  v_cvt_pk_bf16_f32 v134, v60, v61
  v_cvt_pk_bf16_f32 v135, v62, v63
  s_cmp_eq_u32 s55, 0
  s_cbranch_scc0 L_pr_47
  s_setprio 0
L_pr_47:
  v_lshlrev_b32 v4, 7, v1
  s_or_b32 s46, s50, s60
  s_cmp_lg_u32 s46, 0
  s_cbranch_scc1 L_fhi_48
  s_cmp_eq_u32 s26, 6
  s_cbranch_scc0 L_fhi_48
  s_mov_b32 s46, 16842752
  buffer_load_dword v8, v4, s[32:35], s46 offen sc1
  s_mov_b32 s46, 16850944
  buffer_load_dword v9, v4, s[32:35], s46 offen sc1
  s_mov_b32 s46, 16859136
  buffer_load_dword v10, v4, s[32:35], s46 offen sc1
  s_mov_b32 s46, 16867328
  buffer_load_dword v11, v4, s[32:35], s46 offen sc1
L_fhi_48:
  v_mfma_f32_32x32x16_bf16 v[48:63], v[144:147], v[140:143], v[80:95]
  v_exp_f32 v32, v32
  v_exp_f32 v33, v33
  v_mfma_f32_32x32x16_bf16 v[112:127], v[164:167], v[132:135], v[112:127]
  ds_read_b128 v[144:147], v12 offset:2048
  v_exp_f32 v34, v34
  v_exp_f32 v35, v35
  v_exp_f32 v36, v36
  v_exp_f32 v37, v37
  v_exp_f32 v38, v38
  v_exp_f32 v39, v39
  v_cvt_pk_bf16_f32 v128, v32, v33
  v_cvt_pk_bf16_f32 v129, v34, v35
  v_cvt_pk_bf16_f32 v130, v36, v37
  v_cvt_pk_bf16_f32 v131, v38, v39
  ds_read_b64_tr_b16 v[160:161], v3 offset:1024
  ds_read_b64_tr_b16 v[162:163], v3 offset:1280
  ds_read_b64_tr_b16 v[164:165], v3 offset:1536
  ds_read_b64_tr_b16 v[166:167], v3 offset:1792
  v_exp_f32 v40, v40
  v_exp_f32 v41, v41
  v_mfma_f32_32x32x16_bf16 v[96:111], v[152:155], v[128:131], v[96:111]
  v_exp_f32 v42, v42
  v_exp_f32 v43, v43
  v_exp_f32 v44, v44
  v_exp_f32 v45, v45
  v_exp_f32 v46, v46
  v_exp_f32 v47, v47
  v_cvt_pk_bf16_f32 v132, v40, v41
  v_cvt_pk_bf16_f32 v133, v42, v43
  v_cvt_pk_bf16_f32 v134, v44, v45
  v_cvt_pk_bf16_f32 v135, v46, v47
  s_waitcnt lgkmcnt(0)
  v_mfma_f32_32x32x16_bf16 v[32:47], v[148:151], v[136:139], v[64:79]
  v_exp_f32 v48, v48
  v_exp_f32 v49, v49
  v_mfma_f32_32x32x16_bf16 v[96:111], v[156:159], v[132:135], v[96:111]
  v_exp_f32 v50, v50
  v_exp_f32 v51, v51
  v_exp_f32 v52, v52
  v_exp_f32 v53, v53
  v_exp_f32 v54, v54
  v_exp_f32 v55, v55
  v_cvt_pk_bf16_f32 v128, v48, v49
  v_cvt_pk_bf16_f32 v129, v50, v51
  v_cvt_pk_bf16_f32 v130, v52, v53
  v_cvt_pk_bf16_f32 v131, v54, v55
  v_exp_f32 v56, v56
  v_exp_f32 v57, v57
  v_mfma_f32_32x32x16_bf16 v[112:127], v[152:155], v[128:131], v[112:127]
  v_exp_f32 v58, v58
  v_exp_f32 v59, v59
  v_exp_f32 v60, v60
  v_exp_f32 v61, v61
  v_exp_f32 v62, v62
  v_exp_f32 v63, v63
  v_cvt_pk_bf16_f32 v132, v56, v57
  v_cvt_pk_bf16_f32 v133, v58, v59
  v_cvt_pk_bf16_f32 v134, v60, v61
  v_cvt_pk_bf16_f32 v135, v62, v63
  v_mfma_f32_32x32x16_bf16 v[48:63], v[148:151], v[140:143], v[80:95]
  v_exp_f32 v32, v32
  v_exp_f32 v33, v33
  v_mfma_f32_32x32x16_bf16 v[112:127], v[156:159], v[132:135], v[112:127]
  ds_read_b128 v[148:151], v12 offset:3072
  v_exp_f32 v34, v34
  v_exp_f32 v35, v35
  v_exp_f32 v36, v36
  v_exp_f32 v37, v37
  v_exp_f32 v38, v38
  v_exp_f32 v39, v39
  v_cvt_pk_bf16_f32 v128, v32, v33
  v_cvt_pk_bf16_f32 v129, v34, v35
  v_cvt_pk_bf16_f32 v130, v36, v37
  v_cvt_pk_bf16_f32 v131, v38, v39
  ds_read_b64_tr_b16 v[152:153], v3 offset:2048
  ds_read_b64_tr_b16 v[154:155], v3 offset:2304
  ds_read_b64_tr_b16 v[156:157], v3 offset:2560
  ds_read_b64_tr_b16 v[158:159], v3 offset:2816
  v_exp_f32 v40, v40
  v_exp_f32 v41, v41
  v_mfma_f32_32x32x16_bf16 v[96:111], v[160:163], v[128:131], v[96:111]
  v_exp_f32 v42, v42
  v_exp_f32 v43, v43
  v_exp_f32 v44, v44
  v_exp_f32 v45, v45
  v_exp_f32 v46, v46
  v_exp_f32 v47, v47
  v_cvt_pk_bf16_f32 v132, v40, v41
  v_cvt_pk_bf16_f32 v133, v42, v43
  v_cvt_pk_bf16_f32 v134, v44, v45
  v_cvt_pk_bf16_f32 v135, v46, v47
  s_waitcnt lgkmcnt(0)
  v_mfma_f32_32x32x16_bf16 v[32:47], v[144:147], v[136:139], v[64:79]
  v_exp_f32 v48, v48
  v_exp_f32 v49, v49
  v_mfma_f32_32x32x16_bf16 v[96:111], v[164:167], v[132:135], v[96:111]
  v_exp_f32 v50, v50
  v_exp_f32 v51, v51
  v_exp_f32 v52, v52
  v_exp_f32 v53, v53
  v_exp_f32 v54, v54
  v_exp_f32 v55, v55
  v_cvt_pk_bf16_f32 v128, v48, v49
  v_cvt_pk_bf16_f32 v129, v50, v51
  v_cvt_pk_bf16_f32 v130, v52, v53
  v_cvt_pk_bf16_f32 v131, v54, v55
  v_exp_f32 v56, v56
  v_exp_f32 v57, v57
  v_mfma_f32_32x32x16_bf16 v[112:127], v[160:163], v[128:131], v[112:127]
  v_exp_f32 v58, v58
  v_exp_f32 v59, v59
  v_exp_f32 v60, v60
  v_exp_f32 v61, v61
  v_exp_f32 v62, v62
  v_exp_f32 v63, v63
  v_add_u32 v12, 2048, v12
  v_add_u32 v3, v7, v3
  v_cvt_pk_bf16_f32 v132, v56, v57
  v_cvt_pk_bf16_f32 v133, v58, v59
  v_cvt_pk_bf16_f32 v134, v60, v61
  v_cvt_pk_bf16_f32 v135, v62, v63
  s_add_u32 s60, s60, 1
  s_cmp_eq_u32 s50, 0
  s_cbranch_scc1 L_first_sync
  s_cmp_lt_u32 s60, s53
  s_cbranch_scc1 L_body0
  s_branch L_loopdone
L_first_sync:
  v_lshlrev_b32 v4, 7, v1
  s_cmp_eq_u32 s26, 6
  s_cbranch_scc0 L_nofh_49
  s_waitcnt vmcnt(0)
  v_cmp_ne_u32 vcc, s27, v8
  v_cmp_ne_u32 s[62:63], s27, v9
  s_or_b64 vcc, vcc, s[62:63]
  v_cmp_ne_u32 s[62:63], s27, v10
  s_or_b64 vcc, vcc, s[62:63]
  v_cmp_ne_u32 s[62:63], s27, v11
  s_or_b64 vcc, vcc, s[62:63]
  s_nop 4
  s_cbranch_vccz L_fhok_50
  s_mov_b32 s46, 0
L_pfh_51:
  s_mov_b32 s59, 16842752
  buffer_load_dword v8, v4, s[32:35], s59 offen sc1
  s_mov_b32 s59, 16850944
  buffer_load_dword v9, v4, s[32:35], s59 offen sc1
  s_mov_b32 s59, 16859136
  buffer_load_dword v10, v4, s[32:35], s59 offen sc1
  s_mov_b32 s59, 16867328
  buffer_load_dword v11, v4, s[32:35], s59 offen sc1
  s_waitcnt vmcnt(0)
  v_cmp_ne_u32 vcc, s27, v8
  v_cmp_ne_u32 s[62:63], s27, v9
  s_or_b64 vcc, vcc, s[62:63]
  v_cmp_ne_u32 s[62:63], s27, v10
  s_or_b64 vcc, vcc, s[62:63]
  v_cmp_ne_u32 s[62:63], s27, v11
  s_or_b64 vcc, vcc, s[62:63]
  s_add_u32 s46, s46, 1
  s_cmp_ge_u32 s46, 131072
  s_cbranch_scc1 L_pfh_d_52
  s_nop 1
  s_cbranch_vccnz L_pfh_51
L_pfh_d_52:
L_fhok_50:
L_nofh_49:
  s_mov_b32 s59, 0
  s_waitcnt vmcnt(0)
  s_barrier
.p2align 6
L_bodyR:
  s_cmp_eq_u32 s55, 0
  s_cbranch_scc0 L_pr_53
  s_setprio 2
L_pr_53:
  v_mfma_f32_32x32x16_bf16 v[48:63], v[144:147], v[140:143], v[80:95]
  v_exp_f32 v32, v32
  v_exp_f32 v33, v33
  v_mfma_f32_32x32x16_bf16 v[112:127], v[164:167], v[132:135], v[112:127]
  ds_read_b128 v[144:147], v12 offset:2048
  v_exp_f32 v34, v34
  v_exp_f32 v35, v35
  v_exp_f32 v36, v36
  v_exp_f32 v37, v37
  v_exp_f32 v38, v38
  v_exp_f32 v39, v39
  v_cvt_pk_bf16_f32 v128, v32, v33
  v_cvt_pk_bf16_f32 v129, v34, v35
  v_cvt_pk_bf16_f32 v130, v36, v37
  v_cvt_pk_bf16_f32 v131, v38, v39
  ds_read_b64_tr_b16 v[160:161], v3 offset:1024
  ds_read_b64_tr_b16 v[162:163], v3 offset:1280
  ds_read_b64_tr_b16 v[164:165], v3 offset:1536
  ds_read_b64_tr_b16 v[166:167], v3 offset:1792
  v_exp_f32 v40, v40
  v_exp_f32 v41, v41
  v_mfma_f32_32x32x16_bf16 v[96:111], v[152:155], v[128:131], v[96:111]
  v_exp_f32 v42, v42
  v_exp_f32 v43, v43
  s_waitcnt vmcnt(6)
  v_mfma_f32_32x32x16_bf16 v[168:183], v[184:187], v[200:203], v[168:183]
  v_exp_f32 v44, v44
  v_exp_f32 v45, v45
  buffer_load_dwordx4 v[184:187], v2, s[36:39], s59 offen offset:0 sc1
  v_exp_f32 v46, v46
  buffer_load_dwordx4 v[200:203], v2, s[40:43], s59 offen offset:0 sc1
  v_exp_f32 v47, v47
  v_cvt_pk_bf16_f32 v132, v40, v41
  v_cvt_pk_bf16_f32 v133, v42, v43
  v_cvt_pk_bf16_f32 v134, v44, v45
  v_cvt_pk_bf16_f32 v135, v46, v47
  s_waitcnt lgkmcnt(0)
  v_mfma_f32_32x32x16_bf16 v[32:47], v[148:151], v[136:139], v[64:79]
  v_exp_f32 v48, v48
  v_exp_f32 v49, v49
  v_mfma_f32_32x32x16_bf16 v[96:111], v[156:159], v[132:135], v[96:111]
  v_exp_f32 v50, v50
  v_exp_f32 v51, v51
  v_exp_f32 v52, v52
  v_exp_f32 v53, v53
  v_exp_f32 v54, v54
  v_exp_f32 v55, v55
  v_cvt_pk_bf16_f32 v128, v48, v49
  v_cvt_pk_bf16_f32 v129, v50, v51
  v_cvt_pk_bf16_f32 v130, v52, v53
  v_cvt_pk_bf16_f32 v131, v54, v55
  v_exp_f32 v56, v56
  v_exp_f32 v57, v57
  v_mfma_f32_32x32x16_bf16 v[112:127], v[152:155], v[128:131], v[112:127]
  v_exp_f32 v58, v58
  v_exp_f32 v59, v59
  s_waitcnt vmcnt(6)
  v_mfma_f32_32x32x16_bf16 v[168:183], v[188:191], v[204:207], v[168:183]
  v_exp_f32 v60, v60
  v_exp_f32 v61, v61
  buffer_load_dwordx4 v[188:191], v2, s[36:39], s59 offen offset:1024 sc1
  v_exp_f32 v62, v62
  buffer_load_dwordx4 v[204:207], v2, s[40:43], s59 offen offset:1024 sc1
  v_exp_f32 v63, v63
  v_cvt_pk_bf16_f32 v132, v56, v57
  v_cvt_pk_bf16_f32 v133, v58, v59
  v_cvt_pk_bf16_f32 v134, v60, v61
  v_cvt_pk_bf16_f32 v135, v62, v63
  v_mfma_f32_32x32x16_bf16 v[48:63], v[148:151], v[140:143], v[80:95]
  v_exp_f32 v32, v32
  v_exp_f32 v33, v33
  v_mfma_f32_32x32x16_bf16 v[112:127], v[156:159], v[132:135], v[112:127]
  ds_read_b128 v[148:151], v12 offset:3072
  v_exp_f32 v34, v34
  v_exp_f32 v35, v35
  v_exp_f32 v36, v36
  v_exp_f32 v37, v37
  v_exp_f32 v38, v38
  v_exp_f32 v39, v39
  v_cvt_pk_bf16_f32 v128, v32, v33
  v_cvt_pk_bf16_f32 v129, v34, v35
  v_cvt_pk_bf16_f32 v130, v36, v37
  v_cvt_pk_bf16_f32 v131, v38, v39
  ds_read_b64_tr_b16 v[152:153], v3 offset:2048
  ds_read_b64_tr_b16 v[154:155], v3 offset:2304
  ds_read_b64_tr_b16 v[156:157], v3 offset:2560
  ds_read_b64_tr_b16 v[158:159], v3 offset:2816
  v_exp_f32 v40, v40
  v_exp_f32 v41, v41
  v_mfma_f32_32x32x16_bf16 v[96:111], v[160:163], v[128:131], v[96:111]
  v_exp_f32 v42, v42
  v_exp_f32 v43, v43
  s_waitcnt vmcnt(6)
  v_mfma_f32_32x32x16_bf16 v[168:183], v[192:195], v[208:211], v[168:183]
  v_exp_f32 v44, v44
  v_exp_f32 v45, v45
  buffer_load_dwordx4 v[192:195], v2, s[36:39], s59 offen offset:2048 sc1
  v_exp_f32 v46, v46
  buffer_load_dwordx4 v[208:211], v2, s[40:43], s59 offen offset:2048 sc1
  v_exp_f32 v47, v47
  v_cvt_pk_bf16_f32 v132, v40, v41
  v_cvt_pk_bf16_f32 v133, v42, v43
  v_cvt_pk_bf16_f32 v134, v44, v45
  v_cvt_pk_bf16_f32 v135, v46, v47
  s_waitcnt lgkmcnt(0)
  v_mfma_f32_32x32x16_bf16 v[32:47], v[144:147], v[136:139], v[64:79]
  v_exp_f32 v48, v48
  v_exp_f32 v49, v49
  v_mfma_f32_32x32x16_bf16 v[96:111], v[164:167], v[132:135], v[96:111]
  v_exp_f32 v50, v50
  v_exp_f32 v51, v51
  v_exp_f32 v52, v52
  v_exp_f32 v53, v53
  v_exp_f32 v54, v54
  v_exp_f32 v55, v55
  v_cvt_pk_bf16_f32 v128, v48, v49
  v_cvt_pk_bf16_f32 v129, v50, v51
  v_cvt_pk_bf16_f32 v130, v52, v53
  v_cvt_pk_bf16_f32 v131, v54, v55
  v_exp_f32 v56, v56
  v_exp_f32 v57, v57
  v_mfma_f32_32x32x16_bf16 v[112:127], v[160:163], v[128:131], v[112:127]
  v_exp_f32 v58, v58
  v_exp_f32 v59, v59
  s_waitcnt vmcnt(6)
  v_mfma_f32_32x32x16_bf16 v[168:183], v[196:199], v[212:215], v[168:183]
  v_exp_f32 v60, v60
  v_exp_f32 v61, v61
  buffer_load_dwordx4 v[196:199], v2, s[36:39], s59 offen offset:3072 sc1
  v_exp_f32 v62, v62
  buffer_load_dwordx4 v[212:215], v2, s[40:43], s59 offen offset:3072 sc1
  v_exp_f32 v63, v63
  v_add_u32 v12, 2048, v12
  v_add_u32 v3, v7, v3
  s_add_u32 s59, s59, 4096
  v_cvt_pk_bf16_f32 v132, v56, v57
  v_cvt_pk_bf16_f32 v133, v58, v59
  v_cvt_pk_bf16_f32 v134, v60, v61
  v_cvt_pk_bf16_f32 v135, v62, v63
  v_mfma_f32_32x32x16_bf16 v[48:63], v[144:147], v[140:143], v[80:95]
  v_exp_f32 v32, v32
  v_exp_f32 v33, v33
  v_mfma_f32_32x32x16_bf16 v[112:127], v[164:167], v[132:135], v[112:127]
  ds_read_b128 v[144:147], v12 offset:2048
  v_exp_f32 v34, v34
  v_exp_f32 v35, v35
  v_exp_f32 v36, v36
  v_exp_f32 v37, v37
  v_exp_f32 v38, v38
  v_exp_f32 v39, v39
  v_cvt_pk_bf16_f32 v128, v32, v33
  v_cvt_pk_bf16_f32 v129, v34, v35
  v_cvt_pk_bf16_f32 v130, v36, v37
  v_cvt_pk_bf16_f32 v131, v38, v39
  ds_read_b64_tr_b16 v[160:161], v3 offset:1024
  ds_read_b64_tr_b16 v[162:163], v3 offset:1280
  ds_read_b64_tr_b16 v[164:165], v3 offset:1536
  ds_read_b64_tr_b16 v[166:167], v3 offset:1792
  v_exp_f32 v40, v40
  v_exp_f32 v41, v41
  v_mfma_f32_32x32x16_bf16 v[96:111], v[152:155], v[128:131], v[96:111]
  v_exp_f32 v42, v42
  v_exp_f32 v43, v43
  s_waitcnt vmcnt(6)
  v_mfma_f32_32x32x16_bf16 v[168:183], v[184:187], v[200:203], v[168:183]
  v_exp_f32 v44, v44
  v_exp_f32 v45, v45
  buffer_load_dwordx4 v[184:187], v2, s[36:39], s59 offen offset:0 sc1
  v_exp_f32 v46, v46
  buffer_load_dwordx4 v[200:203], v2, s[40:43], s59 offen offset:0 sc1
  v_exp_f32 v47, v47
  v_cvt_pk_bf16_f32 v132, v40, v41
  v_cvt_pk_bf16_f32 v133, v42, v43
  v_cvt_pk_bf16_f32 v134, v44, v45
  v_cvt_pk_bf16_f32 v135, v46, v47
  s_waitcnt lgkmcnt(0)
  v_mfma_f32_32x32x16_bf16 v[32:47], v[148:151], v[136:139], v[64:79]
  v_exp_f32 v48, v48
  v_exp_f32 v49, v49
  v_mfma_f32_32x32x16_bf16 v[96:111], v[156:159], v[132:135], v[96:111]
  v_exp_f32 v50, v50
  v_exp_f32 v51, v51
  v_exp_f32 v52, v52
  v_exp_f32 v53, v53
  v_exp_f32 v54, v54
  v_exp_f32 v55, v55
  v_cvt_pk_bf16_f32 v128, v48, v49
  v_cvt_pk_bf16_f32 v129, v50, v51
  v_cvt_pk_bf16_f32 v130, v52, v53
  v_cvt_pk_bf16_f32 v131, v54, v55
  v_exp_f32 v56, v56
  v_exp_f32 v57, v57
  v_mfma_f32_32x32x16_bf16 v[112:127], v[152:155], v[128:131], v[112:127]
  v_exp_f32 v58, v58
  v_exp_f32 v59, v59
  s_waitcnt vmcnt(6)
  v_mfma_f32_32x32x16_bf16 v[168:183], v[188:191], v[204:207], v[168:183]
  v_exp_f32 v60, v60
  v_exp_f32 v61, v61
  buffer_load_dwordx4 v[188:191], v2, s[36:39], s59 offen offset:1024 sc1
  v_exp_f32 v62, v62
  buffer_load_dwordx4 v[204:207], v2, s[40:43], s59 offen offset:1024 sc1
  v_exp_f32 v63, v63
  v_cvt_pk_bf16_f32 v132, v56, v57
  v_cvt_pk_bf16_f32 v133, v58, v59
  v_cvt_pk_bf16_f32 v134, v60, v61
  v_cvt_pk_bf16_f32 v135, v62, v63
  v_mfma_f32_32x32x16_bf16 v[48:63], v[148:151], v[140:143], v[80:95]
  v_exp_f32 v32, v32
  v_exp_f32 v33, v33
  v_mfma_f32_32x32x16_bf16 v[112:127], v[156:159], v[132:135], v[112:127]
  ds_read_b128 v[148:151], v12 offset:3072
  v_exp_f32 v34, v34
  v_exp_f32 v35, v35
  v_exp_f32 v36, v36
  v_exp_f32 v37, v37
  v_exp_f32 v38, v38
  v_exp_f32 v39, v39
  v_cvt_pk_bf16_f32 v128, v32, v33
  v_cvt_pk_bf16_f32 v129, v34, v35
  v_cvt_pk_bf16_f32 v130, v36, v37
  v_cvt_pk_bf16_f32 v131, v38, v39
  ds_read_b64_tr_b16 v[152:153], v3 offset:2048
  ds_read_b64_tr_b16 v[154:155], v3 offset:2304
  ds_read_b64_tr_b16 v[156:157], v3 offset:2560
  ds_read_b64_tr_b16 v[158:159], v3 offset:2816
  v_exp_f32 v40, v40
  v_exp_f32 v41, v41
  v_mfma_f32_32x32x16_bf16 v[96:111], v[160:163], v[128:131], v[96:111]
  v_exp_f32 v42, v42
  v_exp_f32 v43, v43
  s_waitcnt vmcnt(6)
  v_mfma_f32_32x32x16_bf16 v[168:183], v[192:195], v[208:211], v[168:183]
  v_exp_f32 v44, v44
  v_exp_f32 v45, v45
  buffer_load_dwordx4 v[192:195], v2, s[36:39], s59 offen offset:2048 sc1
  v_exp_f32 v46, v46
  buffer_load_dwordx4 v[208:211], v2, s[40:43], s59 offen offset:2048 sc1
  v_exp_f32 v47, v47
  v_cvt_pk_bf16_f32 v132, v40, v41
  v_cvt_pk_bf16_f32 v133, v42, v43
  v_cvt_pk_bf16_f32 v134, v44, v45
  v_cvt_pk_bf16_f32 v135, v46, v47
  s_waitcnt lgkmcnt(0)
  v_mfma_f32_32x32x16_bf16 v[32:47], v[144:147], v[136:139], v[64:79]
  v_exp_f32 v48, v48
  v_exp_f32 v49, v49
  v_mfma_f32_32x32x16_bf16 v[96:111], v[164:167], v[132:135], v[96:111]
  v_exp_f32 v50, v50
  v_exp_f32 v51, v51
  v_exp_f32 v52, v52
  v_exp_f32 v53, v53
  v_exp_f32 v54, v54
  v_exp_f32 v55, v55
  v_cvt_pk_bf16_f32 v128, v48, v49
  v_cvt_pk_bf16_f32 v129, v50, v51
  v_cvt_pk_bf16_f32 v130, v52, v53
  v_cvt_pk_bf16_f32 v131, v54, v55
  v_exp_f32 v56, v56
  v_exp_f32 v57, v57
  v_mfma_f32_32x32x16_bf16 v[112:127], v[160:163], v[128:131], v[112:127]
  v_exp_f32 v58, v58
  v_exp_f32 v59, v59
  s_waitcnt vmcnt(6)
  v_mfma_f32_32x32x16_bf16 v[168:183], v[196:199], v[212:215], v[168:183]
  v_exp_f32 v60, v60
  v_exp_f32 v61, v61
  buffer_load_dwordx4 v[196:199], v2, s[36:39], s59 offen offset:3072 sc1
  v_exp_f32 v62, v62
  buffer_load_dwordx4 v[212:215], v2, s[40:43], s59 offen offset:3072 sc1
  v_exp_f32 v63, v63
  v_add_u32 v12, 2048, v12
  v_add_u32 v3, v7, v3
  s_add_u32 s59, s59, 4096
  v_cvt_pk_bf16_f32 v132, v56, v57
  v_cvt_pk_bf16_f32 v133, v58, v59
  v_cvt_pk_bf16_f32 v134, v60, v61
  v_cvt_pk_bf16_f32 v135, v62, v63
  v_mfma_f32_32x32x16_bf16 v[48:63], v[144:147], v[140:143], v[80:95]
  v_exp_f32 v32, v32
  v_exp_f32 v33, v33
  v_mfma_f32_32x32x16_bf16 v[112:127], v[164:167], v[132:135], v[112:127]
  ds_read_b128 v[144:147], v12 offset:2048
  v_exp_f32 v34, v34
  v_exp_f32 v35, v35
  v_exp_f32 v36, v36
  v_exp_f32 v37, v37
  v_exp_f32 v38, v38
  v_exp_f32 v39, v39
  v_cvt_pk_bf16_f32 v128, v32, v33
  v_cvt_pk_bf16_f32 v129, v34, v35
  v_cvt_pk_bf16_f32 v130, v36, v37
  v_cvt_pk_bf16_f32 v131, v38, v39
  ds_read_b64_tr_b16 v[160:161], v3 offset:1024
  ds_read_b64_tr_b16 v[162:163], v3 offset:1280
  ds_read_b64_tr_b16 v[164:165], v3 offset:1536
  ds_read_b64_tr_b16 v[166:167], v3 offset:1792
  v_exp_f32 v40, v40
  v_exp_f32 v41, v41
  v_mfma_f32_32x32x16_bf16 v[96:111], v[152:155], v[128:131], v[96:111]
  v_exp_f32 v42, v42
  v_exp_f32 v43, v43
  s_waitcnt vmcnt(6)
  v_mfma_f32_32x32x16_bf16 v[168:183], v[184:187], v[200:203], v[168:183]
  v_exp_f32 v44, v44
  v_exp_f32 v45, v45
  buffer_load_dwordx4 v[184:187], v2, s[36:39], s59 offen offset:0 sc1
  v_exp_f32 v46, v46
  buffer_load_dwordx4 v[200:203], v2, s[40:43], s59 offen offset:0 sc1
  v_exp_f32 v47, v47
  v_cvt_pk_bf16_f32 v132, v40, v41
  v_cvt_pk_bf16_f32 v133, v42, v43
  v_cvt_pk_bf16_f32 v134, v44, v45
  v_cvt_pk_bf16_f32 v135, v46, v47
  s_waitcnt lgkmcnt(0)
  v_mfma_f32_32x32x16_bf16 v[32:47], v[148:151], v[136:139], v[64:79]
  v_exp_f32 v48, v48
  v_exp_f32 v49, v49
  v_mfma_f32_32x32x16_bf16 v[96:111], v[156:159], v[132:135], v[96:111]
  v_exp_f32 v50, v50
  v_exp_f32 v51, v51
  v_exp_f32 v52, v52
  v_exp_f32 v53, v53
  v_exp_f32 v54, v54
  v_exp_f32 v55, v55
  v_cvt_pk_bf16_f32 v128, v48, v49
  v_cvt_pk_bf16_f32 v129, v50, v51
  v_cvt_pk_bf16_f32 v130, v52, v53
  v_cvt_pk_bf16_f32 v131, v54, v55
  v_exp_f32 v56, v56
  v_exp_f32 v57, v57
  v_mfma_f32_32x32x16_bf16 v[112:127], v[152:155], v[128:131], v[112:127]
  v_exp_f32 v58, v58
  v_exp_f32 v59, v59
  s_waitcnt vmcnt(6)
  v_mfma_f32_32x32x16_bf16 v[168:183], v[188:191], v[204:207], v[168:183]
  v_exp_f32 v60, v60
  v_exp_f32 v61, v61
  buffer_load_dwordx4 v[188:191], v2, s[36:39], s59 offen offset:1024 sc1
  v_exp_f32 v62, v62
  buffer_load_dwordx4 v[204:207], v2, s[40:43], s59 offen offset:1024 sc1
  v_exp_f32 v63, v63
  v_cvt_pk_bf16_f32 v132, v56, v57
  v_cvt_pk_bf16_f32 v133, v58, v59
  v_cvt_pk_bf16_f32 v134, v60, v61
  v_cvt_pk_bf16_f32 v135, v62, v63
  v_mfma_f32_32x32x16_bf16 v[48:63], v[148:151], v[140:143], v[80:95]
  v_exp_f32 v32, v32
  v_exp_f32 v33, v33
  v_mfma_f32_32x32x16_bf16 v[112:127], v[156:159], v[132:135], v[112:127]
  ds_read_b128 v[148:151], v12 offset:3072
  v_exp_f32 v34, v34
  v_exp_f32 v35, v35
  v_exp_f32 v36, v36
  v_exp_f32 v37, v37
  v_exp_f32 v38, v38
  v_exp_f32 v39, v39
  v_cvt_pk_bf16_f32 v128, v32, v33
  v_cvt_pk_bf16_f32 v129, v34, v35
  v_cvt_pk_bf16_f32 v130, v36, v37
  v_cvt_pk_bf16_f32 v131, v38, v39
  ds_read_b64_tr_b16 v[152:153], v3 offset:2048
  ds_read_b64_tr_b16 v[154:155], v3 offset:2304
  ds_read_b64_tr_b16 v[156:157], v3 offset:2560
  ds_read_b64_tr_b16 v[158:159], v3 offset:2816
  v_exp_f32 v40, v40
  v_exp_f32 v41, v41
  v_mfma_f32_32x32x16_bf16 v[96:111], v[160:163], v[128:131], v[96:111]
  v_exp_f32 v42, v42
  v_exp_f32 v43, v43
  s_waitcnt vmcnt(6)
  v_mfma_f32_32x32x16_bf16 v[168:183], v[192:195], v[208:211], v[168:183]
  v_exp_f32 v44, v44
  v_exp_f32 v45, v45
  buffer_load_dwordx4 v[192:195], v2, s[36:39], s59 offen offset:2048 sc1
  v_exp_f32 v46, v46
  buffer_load_dwordx4 v[208:211], v2, s[40:43], s59 offen offset:2048 sc1
  v_exp_f32 v47, v47
  v_cvt_pk_bf16_f32 v132, v40, v41
  v_cvt_pk_bf16_f32 v133, v42, v43
  v_cvt_pk_bf16_f32 v134, v44, v45
  v_cvt_pk_bf16_f32 v135, v46, v47
  s_waitcnt lgkmcnt(0)
  v_mfma_f32_32x32x16_bf16 v[32:47], v[144:147], v[136:139], v[64:79]
  v_exp_f32 v48, v48
  v_exp_f32 v49, v49
  v_mfma_f32_32x32x16_bf16 v[96:111], v[164:167], v[132:135], v[96:111]
  v_exp_f32 v50, v50
  v_exp_f32 v51, v51
  v_exp_f32 v52, v52
  v_exp_f32 v53, v53
  v_exp_f32 v54, v54
  v_exp_f32 v55, v55
  v_cvt_pk_bf16_f32 v128, v48, v49
  v_cvt_pk_bf16_f32 v129, v50, v51
  v_cvt_pk_bf16_f32 v130, v52, v53
  v_cvt_pk_bf16_f32 v131, v54, v55
  v_exp_f32 v56, v56
  v_exp_f32 v57, v57
  v_mfma_f32_32x32x16_bf16 v[112:127], v[160:163], v[128:131], v[112:127]
  v_exp_f32 v58, v58
  v_exp_f32 v59, v59
  s_waitcnt vmcnt(6)
  v_mfma_f32_32x32x16_bf16 v[168:183], v[196:199], v[212:215], v[168:183]
  v_exp_f32 v60, v60
  v_exp_f32 v61, v61
  buffer_load_dwordx4 v[196:199], v2, s[36:39], s59 offen offset:3072 sc1
  v_exp_f32 v62, v62
  buffer_load_dwordx4 v[212:215], v2, s[40:43], s59 offen offset:3072 sc1
  v_exp_f32 v63, v63
  v_add_u32 v12, 2048, v12
  v_add_u32 v3, v7, v3
  s_add_u32 s59, s59, 4096
  v_cvt_pk_bf16_f32 v132, v56, v57
  v_cvt_pk_bf16_f32 v133, v58, v59
  v_cvt_pk_bf16_f32 v134, v60, v61
  v_cvt_pk_bf16_f32 v135, v62, v63
  s_cmp_eq_u32 s55, 0
  s_cbranch_scc0 L_pr_54
  s_setprio 0
L_pr_54:
  v_mfma_f32_32x32x16_bf16 v[48:63], v[144:147], v[140:143], v[80:95]
  v_exp_f32 v32, v32
  v_exp_f32 v33, v33
  v_mfma_f32_32x32x16_bf16 v[112:127], v[164:167], v[132:135], v[112:127]
  ds_read_b128 v[144:147], v12 offset:2048
  v_exp_f32 v34, v34
  v_exp_f32 v35, v35
  v_exp_f32 v36, v36
  v_exp_f32 v37, v37
  v_exp_f32 v38, v38
  v_exp_f32 v39, v39
  v_cvt_pk_bf16_f32 v128, v32, v33
  v_cvt_pk_bf16_f32 v129, v34, v35
  v_cvt_pk_bf16_f32 v130, v36, v37
  v_cvt_pk_bf16_f32 v131, v38, v39
  ds_read_b64_tr_b16 v[160:161], v3 offset:1024
  ds_read_b64_tr_b16 v[162:163], v3 offset:1280
  ds_read_b64_tr_b16 v[164:165], v3 offset:1536
  ds_read_b64_tr_b16 v[166:167], v3 offset:1792
  v_exp_f32 v40, v40
  v_exp_f32 v41, v41
  v_mfma_f32_32x32x16_bf16 v[96:111], v[152:155], v[128:131], v[96:111]
  v_exp_f32 v42, v42
  v_exp_f32 v43, v43
  s_waitcnt vmcnt(6)
  v_mfma_f32_32x32x16_bf16 v[168:183], v[184:187], v[200:203], v[168:183]
  v_exp_f32 v44, v44
  v_exp_f32 v45, v45
  buffer_load_dwordx4 v[184:187], v2, s[36:39], s59 offen offset:0 sc1
  v_exp_f32 v46, v46
  buffer_load_dwordx4 v[200:203], v2, s[40:43], s59 offen offset:0 sc1
  v_exp_f32 v47, v47
  v_cvt_pk_bf16_f32 v132, v40, v41
  v_cvt_pk_bf16_f32 v133, v42, v43
  v_cvt_pk_bf16_f32 v134, v44, v45
  v_cvt_pk_bf16_f32 v135, v46, v47
  s_waitcnt lgkmcnt(0)
  v_mfma_f32_32x32x16_bf16 v[32:47], v[148:151], v[136:139], v[64:79]
  v_exp_f32 v48, v48
  v_exp_f32 v49, v49
  v_mfma_f32_32x32x16_bf16 v[96:111], v[156:159], v[132:135], v[96:111]
  v_exp_f32 v50, v50
  v_exp_f32 v51, v51
  v_exp_f32 v52, v52
  v_exp_f32 v53, v53
  v_exp_f32 v54, v54
  v_exp_f32 v55, v55
  v_cvt_pk_bf16_f32 v128, v48, v49
  v_cvt_pk_bf16_f32 v129, v50, v51
  v_cvt_pk_bf16_f32 v130, v52, v53
  v_cvt_pk_bf16_f32 v131, v54, v55
  v_exp_f32 v56, v56
  v_exp_f32 v57, v57
  v_mfma_f32_32x32x16_bf16 v[112:127], v[152:155], v[128:131], v[112:127]
  v_exp_f32 v58, v58
  v_exp_f32 v59, v59
  s_waitcnt vmcnt(6)
  v_mfma_f32_32x32x16_bf16 v[168:183], v[188:191], v[204:207], v[168:183]
  v_exp_f32 v60, v60
  v_exp_f32 v61, v61
  buffer_load_dwordx4 v[188:191], v2, s[36:39], s59 offen offset:1024 sc1
  v_exp_f32 v62, v62
  buffer_load_dwordx4 v[204:207], v2, s[40:43], s59 offen offset:1024 sc1
  v_exp_f32 v63, v63
  v_cvt_pk_bf16_f32 v132, v56, v57
  v_cvt_pk_bf16_f32 v133, v58, v59
  v_cvt_pk_bf16_f32 v134, v60, v61
  v_cvt_pk_bf16_f32 v135, v62, v63
  v_mfma_f32_32x32x16_bf16 v[48:63], v[148:151], v[140:143], v[80:95]
  v_exp_f32 v32, v32
  v_exp_f32 v33, v33
  v_mfma_f32_32x32x16_bf16 v[112:127], v[156:159], v[132:135], v[112:127]
  ds_read_b128 v[148:151], v12 offset:3072
  v_exp_f32 v34, v34
  v_exp_f32 v35, v35
  v_exp_f32 v36, v36
  v_exp_f32 v37, v37
  v_exp_f32 v38, v38
  v_exp_f32 v39, v39
  v_cvt_pk_bf16_f32 v128, v32, v33
  v_cvt_pk_bf16_f32 v129, v34, v35
  v_cvt_pk_bf16_f32 v130, v36, v37
  v_cvt_pk_bf16_f32 v131, v38, v39
  ds_read_b64_tr_b16 v[152:153], v3 offset:2048
  ds_read_b64_tr_b16 v[154:155], v3 offset:2304
  ds_read_b64_tr_b16 v[156:157], v3 offset:2560
  ds_read_b64_tr_b16 v[158:159], v3 offset:2816
  v_exp_f32 v40, v40
  v_exp_f32 v41, v41
  v_mfma_f32_32x32x16_bf16 v[96:111], v[160:163], v[128:131], v[96:111]
  v_exp_f32 v42, v42
  v_exp_f32 v43, v43
  s_waitcnt vmcnt(6)
  v_mfma_f32_32x32x16_bf16 v[168:183], v[192:195], v[208:211], v[168:183]
  v_exp_f32 v44, v44
  v_exp_f32 v45, v45
  buffer_load_dwordx4 v[192:195], v2, s[36:39], s59 offen offset:2048 sc1
  v_exp_f32 v46, v46
  buffer_load_dwordx4 v[208:211], v2, s[40:43], s59 offen offset:2048 sc1
  v_exp_f32 v47, v47
  v_cvt_pk_bf16_f32 v132, v40, v41
  v_cvt_pk_bf16_f32 v133, v42, v43
  v_cvt_pk_bf16_f32 v134, v44, v45
  v_cvt_pk_bf16_f32 v135, v46, v47
  s_waitcnt lgkmcnt(0)
  v_mfma_f32_32x32x16_bf16 v[32:47], v[144:147], v[136:139], v[64:79]
  v_exp_f32 v48, v48
  v_exp_f32 v49, v49
  v_mfma_f32_32x32x16_bf16 v[96:111], v[164:167], v[132:135], v[96:111]
  v_exp_f32 v50, v50
  v_exp_f32 v51, v51
  v_exp_f32 v52, v52
  v_exp_f32 v53, v53
  v_exp_f32 v54, v54
  v_exp_f32 v55, v55
  v_cvt_pk_bf16_f32 v128, v48, v49
  v_cvt_pk_bf16_f32 v129, v50, v51
  v_cvt_pk_bf16_f32 v130, v52, v53
  v_cvt_pk_bf16_f32 v131, v54, v55
  v_exp_f32 v56, v56
  v_exp_f32 v57, v57
  v_mfma_f32_32x32x16_bf16 v[112:127], v[160:163], v[128:131], v[112:127]
  v_exp_f32 v58, v58
  v_exp_f32 v59, v59
  s_waitcnt vmcnt(6)
  v_mfma_f32_32x32x16_bf16 v[168:183], v[196:199], v[212:215], v[168:183]
  v_exp_f32 v60, v60
  v_exp_f32 v61, v61
  buffer_load_dwordx4 v[196:199], v2, s[36:39], s59 offen offset:3072 sc1
  v_exp_f32 v62, v62
  buffer_load_dwordx4 v[212:215], v2, s[40:43], s59 offen offset:3072 sc1
  v_exp_f32 v63, v63
  v_add_u32 v12, 2048, v12
  v_add_u32 v3, v7, v3
  s_add_u32 s59, s59, 4096
  v_cvt_pk_bf16_f32 v132, v56, v57
  v_cvt_pk_bf16_f32 v133, v58, v59
  v_cvt_pk_bf16_f32 v134, v60, v61
  v_cvt_pk_bf16_f32 v135, v62, v63
  s_add_u32 s60, s60, 1
  s_cmp_lt_u32 s60, 3
  s_cbranch_scc1 L_bodyR
  s_mul_i32 s61, s52, 118
  s_lshl_b32 s47, s55, 4
  s_add_u32 s61, s61, s47
  s_lshl_b32 s61, s61, 10
  s_add_u32 s61, s61, 65536
  s_add_u32 s62, s61, 4096
  s_add_u32 s63, s61, 8192
  s_add_u32 s64, s61, 12288
  s_cmp_eq_u32 s55, 0
  s_cbranch_scc0 L_pr_55
  s_setprio 2
L_pr_55:
  v_mfma_f32_32x32x16_bf16 v[48:63], v[144:147], v[140:143], v[80:95]
  v_exp_f32 v32, v32
  v_exp_f32 v33, v33
  v_mfma_f32_32x32x16_bf16 v[112:127], v[164:167], v[132:135], v[112:127]
  ds_read_b128 v[144:147], v12 offset:2048
  v_exp_f32 v34, v34
  v_exp_f32 v35, v35
  v_exp_f32 v36, v36
  v_exp_f32 v37, v37
  v_exp_f32 v38, v38
  v_exp_f32 v39, v39
  v_cvt_pk_bf16_f32 v128, v32, v33
  v_cvt_pk_bf16_f32 v129, v34, v35
  v_cvt_pk_bf16_f32 v130, v36, v37
  v_cvt_pk_bf16_f32 v131, v38, v39
  ds_read_b64_tr_b16 v[160:161], v3 offset:1024
  ds_read_b64_tr_b16 v[162:163], v3 offset:1280
  ds_read_b64_tr_b16 v[164:165], v3 offset:1536
  ds_read_b64_tr_b16 v[166:167], v3 offset:1792
  v_exp_f32 v40, v40
  v_exp_f32 v41, v41
  v_mfma_f32_32x32x16_bf16 v[96:111], v[152:155], v[128:131], v[96:111]
  v_exp_f32 v42, v42
  v_exp_f32 v43, v43
  s_waitcnt vmcnt(6)
  v_mfma_f32_32x32x16_bf16 v[168:183], v[184:187], v[200:203], v[168:183]
  v_exp_f32 v44, v44
  v_exp_f32 v45, v45
  buffer_load_dwordx4 v[184:187], v2, s[36:39], s59 offen offset:0 sc1
  v_exp_f32 v46, v46
  buffer_load_dwordx4 v[200:203], v2, s[40:43], s59 offen offset:0 sc1
  v_exp_f32 v47, v47
  buffer_load_dwordx4 v[216:219], v2, s[32:35], s61 offen offset:0 sc1
  v_cvt_pk_bf16_f32 v132, v40, v41
  v_cvt_pk_bf16_f32 v133, v42, v43
  v_cvt_pk_bf16_f32 v134, v44, v45
  v_cvt_pk_bf16_f32 v135, v46, v47
  s_waitcnt lgkmcnt(0)
  v_mfma_f32_32x32x16_bf16 v[32:47], v[148:151], v[136:139], v[64:79]
  v_exp_f32 v48, v48
  v_exp_f32 v49, v49
  v_mfma_f32_32x32x16_bf16 v[96:111], v[156:159], v[132:135], v[96:111]
  v_exp_f32 v50, v50
  v_exp_f32 v51, v51
  v_exp_f32 v52, v52
  v_exp_f32 v53, v53
  v_exp_f32 v54, v54
  v_exp_f32 v55, v55
  v_cvt_pk_bf16_f32 v128, v48, v49
  v_cvt_pk_bf16_f32 v129, v50, v51
  v_cvt_pk_bf16_f32 v130, v52, v53
  v_cvt_pk_bf16_f32 v131, v54, v55
  v_exp_f32 v56, v56
  v_exp_f32 v57, v57
  v_mfma_f32_32x32x16_bf16 v[112:127], v[152:155], v[128:131], v[112:127]
  v_exp_f32 v58, v58
  v_exp_f32 v59, v59
  s_waitcnt vmcnt(7)
  v_mfma_f32_32x32x16_bf16 v[168:183], v[188:191], v[204:207], v[168:183]
  v_exp_f32 v60, v60
  v_exp_f32 v61, v61
  buffer_load_dwordx4 v[188:191], v2, s[36:39], s59 offen offset:1024 sc1
  v_exp_f32 v62, v62
  buffer_load_dwordx4 v[204:207], v2, s[40:43], s59 offen offset:1024 sc1
  v_exp_f32 v63, v63
  buffer_load_dwordx4 v[220:223], v2, s[32:35], s61 offen offset:1024 sc1
  v_cvt_pk_bf16_f32 v132, v56, v57
  v_cvt_pk_bf16_f32 v133, v58, v59
  v_cvt_pk_bf16_f32 v134, v60, v61
  v_cvt_pk_bf16_f32 v135, v62, v63
  v_mfma_f32_32x32x16_bf16 v[48:63], v[148:151], v[140:143], v[80:95]
  v_exp_f32 v32, v32
  v_exp_f32 v33, v33
  v_mfma_f32_32x32x16_bf16 v[112:127], v[156:159], v[132:135], v[112:127]
  ds_read_b128 v[148:151], v12 offset:3072
  v_exp_f32 v34, v34
  v_exp_f32 v35, v35
  v_exp_f32 v36, v36
  v_exp_f32 v37, v37
  v_exp_f32 v38, v38
  v_exp_f32 v39, v39
  v_cvt_pk_bf16_f32 v128, v32, v33
  v_cvt_pk_bf16_f32 v129, v34, v35
  v_cvt_pk_bf16_f32 v130, v36, v37
  v_cvt_pk_bf16_f32 v131, v38, v39
  ds_read_b64_tr_b16 v[152:153], v3 offset:2048
  ds_read_b64_tr_b16 v[154:155], v3 offset:2304
  ds_read_b64_tr_b16 v[156:157], v3 offset:2560
  ds_read_b64_tr_b16 v[158:159], v3 offset:2816
  v_exp_f32 v40, v40
  v_exp_f32 v41, v41
  v_mfma_f32_32x32x16_bf16 v[96:111], v[160:163], v[128:131], v[96:111]
  v_exp_f32 v42, v42
  v_exp_f32 v43, v43
  s_waitcnt vmcnt(8)
  v_mfma_f32_32x32x16_bf16 v[168:183], v[192:195], v[208:211], v[168:183]
  v_exp_f32 v44, v44
  v_exp_f32 v45, v45
  buffer_load_dwordx4 v[192:195], v2, s[36:39], s59 offen offset:2048 sc1
  v_exp_f32 v46, v46
  buffer_load_dwordx4 v[208:211], v2, s[40:43], s59 offen offset:2048 sc1
  v_exp_f32 v47, v47
  buffer_load_dwordx4 v[224:227], v2, s[32:35], s61 offen offset:2048 sc1
  v_cvt_pk_bf16_f32 v132, v40, v41
  v_cvt_pk_bf16_f32 v133, v42, v43
  v_cvt_pk_bf16_f32 v134, v44, v45
  v_cvt_pk_bf16_f32 v135, v46, v47
  s_waitcnt lgkmcnt(0)
  v_mfma_f32_32x32x16_bf16 v[32:47], v[144:147], v[136:139], v[64:79]
  v_exp_f32 v48, v48
  v_exp_f32 v49, v49
  v_mfma_f32_32x32x16_bf16 v[96:111], v[164:167], v[132:135], v[96:111]
  v_exp_f32 v50, v50
  v_exp_f32 v51, v51
  v_exp_f32 v52, v52
  v_exp_f32 v53, v53
  v_exp_f32 v54, v54
  v_exp_f32 v55, v55
  v_cvt_pk_bf16_f32 v128, v48, v49
  v_cvt_pk_bf16_f32 v129, v50, v51
  v_cvt_pk_bf16_f32 v130, v52, v53
  v_cvt_pk_bf16_f32 v131, v54, v55
  v_exp_f32 v56, v56
  v_exp_f32 v57, v57
  v_mfma_f32_32x32x16_bf16 v[112:127], v[160:163], v[128:131], v[112:127]
  v_exp_f32 v58, v58
  v_exp_f32 v59, v59
  s_waitcnt vmcnt(9)
  v_mfma_f32_32x32x16_bf16 v[168:183], v[196:199], v[212:215], v[168:183]
  v_exp_f32 v60, v60
  v_exp_f32 v61, v61
  buffer_load_dwordx4 v[196:199], v2, s[36:39], s59 offen offset:3072 sc1
  v_exp_f32 v62, v62
  buffer_load_dwordx4 v[212:215], v2, s[40:43], s59 offen offset:3072 sc1
  v_exp_f32 v63, v63
  buffer_load_dwordx4 v[228:231], v2, s[32:35], s61 offen offset:3072 sc1
  v_add_u32 v12, 2048, v12
  v_add_u32 v3, v7, v3
  s_add_u32 s59, s59, 4096
  v_cvt_pk_bf16_f32 v132, v56, v57
  v_cvt_pk_bf16_f32 v133, v58, v59
  v_cvt_pk_bf16_f32 v134, v60, v61
  v_cvt_pk_bf16_f32 v135, v62, v63
  v_mfma_f32_32x32x16_bf16 v[48:63], v[144:147], v[140:143], v[80:95]
  v_exp_f32 v32, v32
  v_exp_f32 v33, v33
  v_mfma_f32_32x32x16_bf16 v[112:127], v[164:167], v[132:135], v[112:127]
  ds_read_b128 v[144:147], v12 offset:2048
  v_exp_f32 v34, v34
  v_exp_f32 v35, v35
  v_exp_f32 v36, v36
  v_exp_f32 v37, v37
  v_exp_f32 v38, v38
  v_exp_f32 v39, v39
  v_cvt_pk_bf16_f32 v128, v32, v33
  v_cvt_pk_bf16_f32 v129, v34, v35
  v_cvt_pk_bf16_f32 v130, v36, v37
  v_cvt_pk_bf16_f32 v131, v38, v39
  ds_read_b64_tr_b16 v[160:161], v3 offset:1024
  ds_read_b64_tr_b16 v[162:163], v3 offset:1280
  ds_read_b64_tr_b16 v[164:165], v3 offset:1536
  ds_read_b64_tr_b16 v[166:167], v3 offset:1792
  v_exp_f32 v40, v40
  v_exp_f32 v41, v41
  v_mfma_f32_32x32x16_bf16 v[96:111], v[152:155], v[128:131], v[96:111]
  v_exp_f32 v42, v42
  v_exp_f32 v43, v43
  s_waitcnt vmcnt(10)
  v_mfma_f32_32x32x16_bf16 v[168:183], v[184:187], v[200:203], v[168:183]
  v_exp_f32 v44, v44
  v_exp_f32 v45, v45
  buffer_load_dwordx4 v[184:187], v2, s[36:39], s59 offen offset:0 sc1
  v_exp_f32 v46, v46
  buffer_load_dwordx4 v[200:203], v2, s[40:43], s59 offen offset:0 sc1
  v_exp_f32 v47, v47
  buffer_load_dwordx4 v[232:235], v2, s[32:35], s62 offen offset:0 sc1
  v_cvt_pk_bf16_f32 v132, v40, v41
  v_cvt_pk_bf16_f32 v133, v42, v43
  v_cvt_pk_bf16_f32 v134, v44, v45
  v_cvt_pk_bf16_f32 v135, v46, v47
  s_waitcnt lgkmcnt(0)
  v_mfma_f32_32x32x16_bf16 v[32:47], v[148:151], v[136:139], v[64:79]
  v_exp_f32 v48, v48
  v_exp_f32 v49, v49
  v_mfma_f32_32x32x16_bf16 v[96:111], v[156:159], v[132:135], v[96:111]
  v_exp_f32 v50, v50
  v_exp_f32 v51, v51
  v_exp_f32 v52, v52
  v_exp_f32 v53, v53
  v_exp_f32 v54, v54
  v_exp_f32 v55, v55
  v_cvt_pk_bf16_f32 v128, v48, v49
  v_cvt_pk_bf16_f32 v129, v50, v51
  v_cvt_pk_bf16_f32 v130, v52, v53
  v_cvt_pk_bf16_f32 v131, v54, v55
  v_exp_f32 v56, v56
  v_exp_f32 v57, v57
  v_mfma_f32_32x32x16_bf16 v[112:127], v[152:155], v[128:131], v[112:127]
  v_exp_f32 v58, v58
  v_exp_f32 v59, v59
  s_waitcnt vmcnt(10)
  v_mfma_f32_32x32x16_bf16 v[168:183], v[188:191], v[204:207], v[168:183]
  v_exp_f32 v60, v60
  v_exp_f32 v61, v61
  buffer_load_dwordx4 v[188:191], v2, s[36:39], s59 offen offset:1024 sc1
  v_exp_f32 v62, v62
  buffer_load_dwordx4 v[204:207], v2, s[40:43], s59 offen offset:1024 sc1
  v_exp_f32 v63, v63
  buffer_load_dwordx4 v[236:239], v2, s[32:35], s62 offen offset:1024 sc1
  v_cvt_pk_bf16_f32 v132, v56, v57
  v_cvt_pk_bf16_f32 v133, v58, v59
  v_cvt_pk_bf16_f32 v134, v60, v61
  v_cvt_pk_bf16_f32 v135, v62, v63
  v_mfma_f32_32x32x16_bf16 v[48:63], v[148:151], v[140:143], v[80:95]
  v_exp_f32 v32, v32
  v_exp_f32 v33, v33
  v_mfma_f32_32x32x16_bf16 v[112:127], v[156:159], v[132:135], v[112:127]
  ds_read_b128 v[148:151], v12 offset:3072
  v_exp_f32 v34, v34
  v_exp_f32 v35, v35
  v_exp_f32 v36, v36
  v_exp_f32 v37, v37
  v_exp_f32 v38, v38
  v_exp_f32 v39, v39
  v_cvt_pk_bf16_f32 v128, v32, v33
  v_cvt_pk_bf16_f32 v129, v34, v35
  v_cvt_pk_bf16_f32 v130, v36, v37
  v_cvt_pk_bf16_f32 v131, v38, v39
  ds_read_b64_tr_b16 v[152:153], v3 offset:2048
  ds_read_b64_tr_b16 v[154:155], v3 offset:2304
  ds_read_b64_tr_b16 v[156:157], v3 offset:2560
  ds_read_b64_tr_b16 v[158:159], v3 offset:2816
  v_exp_f32 v40, v40
  v_exp_f32 v41, v41
  v_mfma_f32_32x32x16_bf16 v[96:111], v[160:163], v[128:131], v[96:111]
  v_exp_f32 v42, v42
  v_exp_f32 v43, v43
  s_waitcnt vmcnt(10)
  v_mfma_f32_32x32x16_bf16 v[168:183], v[192:195], v[208:211], v[168:183]
  v_exp_f32 v44, v44
  v_exp_f32 v45, v45
  buffer_load_dwordx4 v[192:195], v2, s[36:39], s59 offen offset:2048 sc1
  v_exp_f32 v46, v46
  buffer_load_dwordx4 v[208:211], v2, s[40:43], s59 offen offset:2048 sc1
  v_exp_f32 v47, v47
  buffer_load_dwordx4 v[240:243], v2, s[32:35], s62 offen offset:2048 sc1
  v_cvt_pk_bf16_f32 v132, v40, v41
  v_cvt_pk_bf16_f32 v133, v42, v43
  v_cvt_pk_bf16_f32 v134, v44, v45
  v_cvt_pk_bf16_f32 v135, v46, v47
  s_waitcnt lgkmcnt(0)
  v_mfma_f32_32x32x16_bf16 v[32:47], v[144:147], v[136:139], v[64:79]
  v_exp_f32 v48, v48
  v_exp_f32 v49, v49
  v_mfma_f32_32x32x16_bf16 v[96:111], v[164:167], v[132:135], v[96:111]
  v_exp_f32 v50, v50
  v_exp_f32 v51, v51
  v_exp_f32 v52, v52
  v_exp_f32 v53, v53
  v_exp_f32 v54, v54
  v_exp_f32 v55, v55
  v_cvt_pk_bf16_f32 v128, v48, v49
  v_cvt_pk_bf16_f32 v129, v50, v51
  v_cvt_pk_bf16_f32 v130, v52, v53
  v_cvt_pk_bf16_f32 v131, v54, v55
  v_exp_f32 v56, v56
  v_exp_f32 v57, v57
  v_mfma_f32_32x32x16_bf16 v[112:127], v[160:163], v[128:131], v[112:127]
  v_exp_f32 v58, v58
  v_exp_f32 v59, v59
  s_waitcnt vmcnt(10)
  v_mfma_f32_32x32x16_bf16 v[168:183], v[196:199], v[212:215], v[168:183]
  v_exp_f32 v60, v60
  v_exp_f32 v61, v61
  buffer_load_dwordx4 v[196:199], v2, s[36:39], s59 offen offset:3072 sc1
  v_exp_f32 v62, v62
  buffer_load_dwordx4 v[212:215], v2, s[40:43], s59 offen offset:3072 sc1
  v_exp_f32 v63, v63
  buffer_load_dwordx4 v[244:247], v2, s[32:35], s62 offen offset:3072 sc1
  v_add_u32 v12, 2048, v12
  v_add_u32 v3, v7, v3
  s_add_u32 s59, s59, 4096
  v_cvt_pk_bf16_f32 v132, v56, v57
  v_cvt_pk_bf16_f32 v133, v58, v59
  v_cvt_pk_bf16_f32 v134, v60, v61
  v_cvt_pk_bf16_f32 v135, v62, v63
  s_cmp_eq_u32 s55, 0
  s_cbranch_scc0 L_pr_56
  s_setprio 0
L_pr_56:
  v_mfma_f32_32x32x16_bf16 v[48:63], v[144:147], v[140:143], v[80:95]
  v_exp_f32 v32, v32
  v_exp_f32 v33, v33
  v_mfma_f32_32x32x16_bf16 v[112:127], v[164:167], v[132:135], v[112:127]
  ds_read_b128 v[144:147], v12 offset:2048
  v_exp_f32 v34, v34
  v_exp_f32 v35, v35
  v_exp_f32 v36, v36
  v_exp_f32 v37, v37
  v_exp_f32 v38, v38
  v_exp_f32 v39, v39
  v_cvt_pk_bf16_f32 v128, v32, v33
  v_cvt_pk_bf16_f32 v129, v34, v35
  v_cvt_pk_bf16_f32 v130, v36, v37
  v_cvt_pk_bf16_f32 v131, v38, v39
  ds_read_b64_tr_b16 v[160:161], v3 offset:1024
  ds_read_b64_tr_b16 v[162:163], v3 offset:1280
  ds_read_b64_tr_b16 v[164:165], v3 offset:1536
  ds_read_b64_tr_b16 v[166:167], v3 offset:1792
  v_exp_f32 v40, v40
  v_exp_f32 v41, v41
  v_mfma_f32_32x32x16_bf16 v[96:111], v[152:155], v[128:131], v[96:111]
  v_exp_f32 v42, v42
  v_exp_f32 v43, v43
  s_waitcnt vmcnt(10)
  v_mfma_f32_32x32x16_bf16 v[168:183], v[184:187], v[200:203], v[168:183]
  v_exp_f32 v44, v44
  v_exp_f32 v45, v45
  buffer_load_dwordx4 v[184:187], v2, s[36:39], s59 offen offset:0 sc1
  v_exp_f32 v46, v46
  buffer_load_dwordx4 v[200:203], v2, s[40:43], s59 offen offset:0 sc1
  v_exp_f32 v47, v47
  v_cvt_pk_bf16_f32 v132, v40, v41
  v_cvt_pk_bf16_f32 v133, v42, v43
  v_cvt_pk_bf16_f32 v134, v44, v45
  v_cvt_pk_bf16_f32 v135, v46, v47
  s_waitcnt lgkmcnt(0)
  v_mfma_f32_32x32x16_bf16 v[32:47], v[148:151], v[136:139], v[64:79]
  v_exp_f32 v48, v48
  v_exp_f32 v49, v49
  v_mfma_f32_32x32x16_bf16 v[96:111], v[156:159], v[132:135], v[96:111]
  v_exp_f32 v50, v50
  v_exp_f32 v51, v51
  v_exp_f32 v52, v52
  v_exp_f32 v53, v53
  v_exp_f32 v54, v54
  v_exp_f32 v55, v55
  v_cvt_pk_bf16_f32 v128, v48, v49
  v_cvt_pk_bf16_f32 v129, v50, v51
  v_cvt_pk_bf16_f32 v130, v52, v53
  v_cvt_pk_bf16_f32 v131, v54, v55
  v_exp_f32 v56, v56
  v_exp_f32 v57, v57
  v_mfma_f32_32x32x16_bf16 v[112:127], v[152:155], v[128:131], v[112:127]
  v_exp_f32 v58, v58
  v_exp_f32 v59, v59
  s_waitcnt vmcnt(9)
  v_mfma_f32_32x32x16_bf16 v[168:183], v[188:191], v[204:207], v[168:183]
  v_exp_f32 v60, v60
  v_exp_f32 v61, v61
  buffer_load_dwordx4 v[188:191], v2, s[36:39], s59 offen offset:1024 sc1
  v_exp_f32 v62, v62
  buffer_load_dwordx4 v[204:207], v2, s[40:43], s59 offen offset:1024 sc1
  v_exp_f32 v63, v63
  v_cvt_pk_bf16_f32 v132, v56, v57
  v_cvt_pk_bf16_f32 v133, v58, v59
  v_cvt_pk_bf16_f32 v134, v60, v61
  v_cvt_pk_bf16_f32 v135, v62, v63
  v_mfma_f32_32x32x16_bf16 v[48:63], v[148:151], v[140:143], v[80:95]
  v_exp_f32 v32, v32
  v_exp_f32 v33, v33
  v_mfma_f32_32x32x16_bf16 v[112:127], v[156:159], v[132:135], v[112:127]
  ds_read_b128 v[148:151], v12 offset:3072
  v_exp_f32 v34, v34
  v_exp_f32 v35, v35
  v_exp_f32 v36, v36
  v_exp_f32 v37, v37
  v_exp_f32 v38, v38
  v_exp_f32 v39, v39
  v_cvt_pk_bf16_f32 v128, v32, v33
  v_cvt_pk_bf16_f32 v129, v34, v35
  v_cvt_pk_bf16_f32 v130, v36, v37
  v_cvt_pk_bf16_f32 v131, v38, v39
  ds_read_b64_tr_b16 v[152:153], v3 offset:2048
  ds_read_b64_tr_b16 v[154:155], v3 offset:2304
  ds_read_b64_tr_b16 v[156:157], v3 offset:2560
  ds_read_b64_tr_b16 v[158:159], v3 offset:2816
  v_exp_f32 v40, v40
  v_exp_f32 v41, v41
  v_mfma_f32_32x32x16_bf16 v[96:111], v[160:163], v[128:131], v[96:111]
  v_exp_f32 v42, v42
  v_exp_f32 v43, v43
  s_waitcnt vmcnt(8)
  v_mfma_f32_32x32x16_bf16 v[168:183], v[192:195], v[208:211], v[168:183]
  v_exp_f32 v44, v44
  v_exp_f32 v45, v45
  buffer_load_dwordx4 v[192:195], v2, s[36:39], s59 offen offset:2048 sc1
  v_exp_f32 v46, v46
  buffer_load_dwordx4 v[208:211], v2, s[40:43], s59 offen offset:2048 sc1
  v_exp_f32 v47, v47
  v_cvt_pk_bf16_f32 v132, v40, v41
  v_cvt_pk_bf16_f32 v133, v42, v43
  v_cvt_pk_bf16_f32 v134, v44, v45
  v_cvt_pk_bf16_f32 v135, v46, v47
  s_waitcnt lgkmcnt(0)
  v_mfma_f32_32x32x16_bf16 v[32:47], v[144:147], v[136:139], v[64:79]
  v_exp_f32 v48, v48
  v_exp_f32 v49, v49
  v_mfma_f32_32x32x16_bf16 v[96:111], v[164:167], v[132:135], v[96:111]
  v_exp_f32 v50, v50
  v_exp_f32 v51, v51
  v_exp_f32 v52, v52
  v_exp_f32 v53, v53
  v_exp_f32 v54, v54
  v_exp_f32 v55, v55
  v_cvt_pk_bf16_f32 v128, v48, v49
  v_cvt_pk_bf16_f32 v129, v50, v51
  v_cvt_pk_bf16_f32 v130, v52, v53
  v_cvt_pk_bf16_f32 v131, v54, v55
  v_exp_f32 v56, v56
  v_exp_f32 v57, v57
  v_mfma_f32_32x32x16_bf16 v[112:127], v[160:163], v[128:131], v[112:127]
  v_exp_f32 v58, v58
  v_exp_f32 v59, v59
  s_waitcnt vmcnt(7)
  v_mfma_f32_32x32x16_bf16 v[168:183], v[196:199], v[212:215], v[168:183]
  v_exp_f32 v60, v60
  v_exp_f32 v61, v61
  buffer_load_dwordx4 v[196:199], v2, s[36:39], s59 offen offset:3072 sc1
  v_exp_f32 v62, v62
  buffer_load_dwordx4 v[212:215], v2, s[40:43], s59 offen offset:3072 sc1
  v_exp_f32 v63, v63
  v_add_u32 v12, 2048, v12
  v_add_u32 v3, v7, v3
  s_add_u32 s59, s59, 4096
  v_cvt_pk_bf16_f32 v132, v56, v57
  v_cvt_pk_bf16_f32 v133, v58, v59
  v_cvt_pk_bf16_f32 v134, v60, v61
  v_cvt_pk_bf16_f32 v135, v62, v63
  v_mfma_f32_32x32x16_bf16 v[48:63], v[144:147], v[140:143], v[80:95]
  v_exp_f32 v32, v32
  v_exp_f32 v33, v33
  v_mfma_f32_32x32x16_bf16 v[112:127], v[164:167], v[132:135], v[112:127]
  ds_read_b128 v[144:147], v12 offset:2048
  v_exp_f32 v34, v34
  v_exp_f32 v35, v35
  v_exp_f32 v36, v36
  v_exp_f32 v37, v37
  v_exp_f32 v38, v38
  v_exp_f32 v39, v39
  v_cvt_pk_bf16_f32 v128, v32, v33
  v_cvt_pk_bf16_f32 v129, v34, v35
  v_cvt_pk_bf16_f32 v130, v36, v37
  v_cvt_pk_bf16_f32 v131, v38, v39
  ds_read_b64_tr_b16 v[160:161], v3 offset:1024
  ds_read_b64_tr_b16 v[162:163], v3 offset:1280
  ds_read_b64_tr_b16 v[164:165], v3 offset:1536
  ds_read_b64_tr_b16 v[166:167], v3 offset:1792
  v_exp_f32 v40, v40
  v_exp_f32 v41, v41
  v_mfma_f32_32x32x16_bf16 v[96:111], v[152:155], v[128:131], v[96:111]
  v_exp_f32 v42, v42
  v_exp_f32 v43, v43
  s_waitcnt vmcnt(6)
  v_mfma_f32_32x32x16_bf16 v[168:183], v[184:187], v[200:203], v[168:183]
  v_exp_f32 v44, v44
  v_exp_f32 v45, v45
  buffer_load_dwordx4 v[184:187], v2, s[32:35], s63 offen offset:0 sc1
  v_exp_f32 v46, v46
  buffer_load_dwordx4 v[200:203], v2, s[32:35], s64 offen offset:0 sc1
  v_exp_f32 v47, v47
  v_cvt_pk_bf16_f32 v132, v40, v41
  v_cvt_pk_bf16_f32 v133, v42, v43
  v_cvt_pk_bf16_f32 v134, v44, v45
  v_cvt_pk_bf16_f32 v135, v46, v47
  s_waitcnt lgkmcnt(0)
  v_mfma_f32_32x32x16_bf16 v[32:47], v[148:151], v[136:139], v[64:79]
  v_exp_f32 v48, v48
  v_exp_f32 v49, v49
  v_mfma_f32_32x32x16_bf16 v[96:111], v[156:159], v[132:135], v[96:111]
  v_exp_f32 v50, v50
  v_exp_f32 v51, v51
  v_exp_f32 v52, v52
  v_exp_f32 v53, v53
  v_exp_f32 v54, v54
  v_exp_f32 v55, v55
  v_cvt_pk_bf16_f32 v128, v48, v49
  v_cvt_pk_bf16_f32 v129, v50, v51
  v_cvt_pk_bf16_f32 v130, v52, v53
  v_cvt_pk_bf16_f32 v131, v54, v55
  v_exp_f32 v56, v56
  v_exp_f32 v57, v57
  v_mfma_f32_32x32x16_bf16 v[112:127], v[152:155], v[128:131], v[112:127]
  v_exp_f32 v58, v58
  v_exp_f32 v59, v59
  s_waitcnt vmcnt(6)
  v_mfma_f32_32x32x16_bf16 v[168:183], v[188:191], v[204:207], v[168:183]
  v_exp_f32 v60, v60
  v_exp_f32 v61, v61
  buffer_load_dwordx4 v[188:191], v2, s[32:35], s63 offen offset:1024 sc1
  v_exp_f32 v62, v62
  buffer_load_dwordx4 v[204:207], v2, s[32:35], s64 offen offset:1024 sc1
  v_exp_f32 v63, v63
  v_cvt_pk_bf16_f32 v132, v56, v57
  v_cvt_pk_bf16_f32 v133, v58, v59
  v_cvt_pk_bf16_f32 v134, v60, v61
  v_cvt_pk_bf16_f32 v135, v62, v63
  v_mfma_f32_32x32x16_bf16 v[48:63], v[148:151], v[140:143], v[80:95]
  v_exp_f32 v32, v32
  v_exp_f32 v33, v33
  v_mfma_f32_32x32x16_bf16 v[112:127], v[156:159], v[132:135], v[112:127]
  ds_read_b128 v[148:151], v12 offset:3072
  v_exp_f32 v34, v34
  v_exp_f32 v35, v35
  v_exp_f32 v36, v36
  v_exp_f32 v37, v37
  v_exp_f32 v38, v38
  v_exp_f32 v39, v39
  v_cvt_pk_bf16_f32 v128, v32, v33
  v_cvt_pk_bf16_f32 v129, v34, v35
  v_cvt_pk_bf16_f32 v130, v36, v37
  v_cvt_pk_bf16_f32 v131, v38, v39
  ds_read_b64_tr_b16 v[152:153], v3 offset:2048
  ds_read_b64_tr_b16 v[154:155], v3 offset:2304
  ds_read_b64_tr_b16 v[156:157], v3 offset:2560
  ds_read_b64_tr_b16 v[158:159], v3 offset:2816
  v_exp_f32 v40, v40
  v_exp_f32 v41, v41
  v_mfma_f32_32x32x16_bf16 v[96:111], v[160:163], v[128:131], v[96:111]
  v_exp_f32 v42, v42
  v_exp_f32 v43, v43
  s_waitcnt vmcnt(6)
  v_mfma_f32_32x32x16_bf16 v[168:183], v[192:195], v[208:211], v[168:183]
  v_exp_f32 v44, v44
  v_exp_f32 v45, v45
  buffer_load_dwordx4 v[192:195], v2, s[32:35], s63 offen offset:2048 sc1
  v_exp_f32 v46, v46
  buffer_load_dwordx4 v[208:211], v2, s[32:35], s64 offen offset:2048 sc1
  v_exp_f32 v47, v47
  v_cvt_pk_bf16_f32 v132, v40, v41
  v_cvt_pk_bf16_f32 v133, v42, v43
  v_cvt_pk_bf16_f32 v134, v44, v45
  v_cvt_pk_bf16_f32 v135, v46, v47
  s_waitcnt lgkmcnt(0)
  v_mfma_f32_32x32x16_bf16 v[32:47], v[144:147], v[136:139], v[64:79]
  v_exp_f32 v48, v48
  v_exp_f32 v49, v49
  v_mfma_f32_32x32x16_bf16 v[96:111], v[164:167], v[132:135], v[96:111]
  v_exp_f32 v50, v50
  v_exp_f32 v51, v51
  v_exp_f32 v52, v52
  v_exp_f32 v53, v53
  v_exp_f32 v54, v54
  v_exp_f32 v55, v55
  v_cvt_pk_bf16_f32 v128, v48, v49
  v_cvt_pk_bf16_f32 v129, v50, v51
  v_cvt_pk_bf16_f32 v130, v52, v53
  v_cvt_pk_bf16_f32 v131, v54, v55
  v_exp_f32 v56, v56
  v_exp_f32 v57, v57
  v_mfma_f32_32x32x16_bf16 v[112:127], v[160:163], v[128:131], v[112:127]
  v_exp_f32 v58, v58
  v_exp_f32 v59, v59
  s_waitcnt vmcnt(6)
  v_mfma_f32_32x32x16_bf16 v[168:183], v[196:199], v[212:215], v[168:183]
  v_exp_f32 v60, v60
  v_exp_f32 v61, v61
  buffer_load_dwordx4 v[196:199], v2, s[32:35], s63 offen offset:3072 sc1
  v_exp_f32 v62, v62
  buffer_load_dwordx4 v[212:215], v2, s[32:35], s64 offen offset:3072 sc1
  v_exp_f32 v63, v63
  v_add_u32 v12, 2048, v12
  v_add_u32 v3, v7, v3
  s_add_u32 s59, s59, 4096
  v_cvt_pk_bf16_f32 v132, v56, v57
  v_cvt_pk_bf16_f32 v133, v58, v59
  v_cvt_pk_bf16_f32 v134, v60, v61
  v_cvt_pk_bf16_f32 v135, v62, v63
L_loopdone:
  s_setprio 0
  s_nop 0
  v_mfma_f32_32x32x16_bf16 v[112:127], v[164:167], v[132:135], v[112:127]
  s_waitcnt lgkmcnt(0)
  s_nop 12
  v_mov_b32 v10, v104
  s_nop 1
  v_permlane32_swap_b32 v104, v10
  s_nop 1
  v_mov_b32 v10, v120
  s_nop 1
  v_permlane32_swap_b32 v120, v10
  s_nop 1
  s_cmp_eq_u32 s50, 1
  s_cbranch_scc1 L_ok
  s_mul_i32 s46, s54, 6144
  s_add_u32 s46, s46, 135168
  v_add_u32 v10, s46, v2
  s_cmp_eq_u32 s55, 0
  s_cbranch_scc1 L_xread
  ds_write_b128 v10, v[96:99] offset:0
  ds_write_b128 v10, v[100:103] offset:1024
  ds_write_b128 v10, v[104:107] offset:2048
  ds_write_b128 v10, v[112:115] offset:3072
  ds_write_b128 v10, v[116:119] offset:4096
  ds_write_b128 v10, v[120:123] offset:5120
  s_waitcnt lgkmcnt(0)
  s_barrier
  s_barrier
  s_branch L_x2b
L_xread:
  s_barrier
  ds_read_b128 v[32:35], v10 offset:0
  ds_read_b128 v[36:39], v10 offset:1024
  ds_read_b128 v[40:43], v10 offset:2048
  ds_read_b128 v[44:47], v10 offset:3072
  ds_read_b128 v[48:51], v10 offset:4096
  ds_read_b128 v[52:55], v10 offset:5120
  s_waitcnt lgkmcnt(0)
  v_add_f32 v96, v96, v32
  v_add_f32 v97, v97, v33
  v_add_f32 v98, v98, v34
  v_add_f32 v99, v99, v35
  v_add_f32 v100, v100, v36
  v_add_f32 v101, v101, v37
  v_add_f32 v102, v102, v38
  v_add_f32 v103, v103, v39
  v_add_f32 v104, v104, v40
  v_add_f32 v112, v112, v44
  v_add_f32 v113, v113, v45
  v_add_f32 v114, v114, v46
  v_add_f32 v115, v115, v47
  v_add_f32 v116, v116, v48
  v_add_f32 v117, v117, v49
  v_add_f32 v118, v118, v50
  v_add_f32 v119, v119, v51
  v_add_f32 v120, v120, v52
L_ok:
  s_mul_i32 s46, s58, 118
  s_add_u32 s46, s46, s56
  s_lshl_b32 s46, s46, 10
  s_add_u32 s46, s46, 8388608
  v_rcp_f32 v8, v104
  s_nop 0
  v_mul_f32 v96, v96, v8
  v_mul_f32 v97, v97, v8
  v_mul_f32 v98, v98, v8
  v_mul_f32 v99, v99, v8
  v_mul_f32 v100, v100, v8
  v_mul_f32 v101, v101, v8
  v_mul_f32 v102, v102, v8
  v_mul_f32 v103, v103, v8
  v_cvt_pk_bf16_f32 v128, v96, v97
  v_cvt_pk_bf16_f32 v129, v98, v99
  v_cvt_pk_bf16_f32 v130, v100, v101
  v_cvt_pk_bf16_f32 v131, v102, v103
  buffer_store_dwordx4 v[128:131], v2, s[32:35], s46 offen sc1
  s_add_u32 s46, s46, 120832
  v_rcp_f32 v8, v120
  s_nop 0
  v_mul_f32 v112, v112, v8
  v_mul_f32 v113, v113, v8
  v_mul_f32 v114, v114, v8
  v_mul_f32 v115, v115, v8
  v_mul_f32 v116, v116, v8
  v_mul_f32 v117, v117, v8
  v_mul_f32 v118, v118, v8
  v_mul_f32 v119, v119, v8
  v_cvt_pk_bf16_f32 v132, v112, v113
  v_cvt_pk_bf16_f32 v133, v114, v115
  v_cvt_pk_bf16_f32 v134, v116, v117
  v_cvt_pk_bf16_f32 v135, v118, v119
  buffer_store_dwordx4 v[132:135], v2, s[32:35], s46 offen sc1
  s_add_u32 s46, s46, 120832
  s_cmp_eq_u32 s50, 1
  s_cbranch_scc1 L_good
  v_add_f32 v15, v96, v112
  v_add_f32 v10, v97, v113
  v_add_f32 v15, v15, v10
  v_add_f32 v10, v98, v114
  v_add_f32 v15, v15, v10
  v_add_f32 v10, v99, v115
  v_add_f32 v15, v15, v10
  v_add_f32 v10, v100, v116
  v_add_f32 v15, v15, v10
  v_add_f32 v10, v101, v117
  v_add_f32 v15, v15, v10
  v_add_f32 v10, v102, v118
  v_add_f32 v15, v15, v10
  v_add_f32 v10, v103, v119
  v_add_f32 v15, v15, v10
  v_max_f32 v8, v104, v120
  v_add_f32 v9, v104, v120
  v_mov_b32 v10, 0x5d800000
  v_mov_b32 v11, 0x7f800000
  v_cmp_nlt_f32 vcc, v8, v10
  v_cmp_nlt_f32 s[62:63], abs(v15), v11
  v_cmp_u_f32 s[64:65], v9, v9
  s_nop 0
  s_or_b64 vcc, vcc, s[62:63]
  s_or_b64 vcc, vcc, s[64:65]
  s_nop 4
  s_cbranch_vccz L_good
  s_waitcnt vmcnt(0)
  s_mov_b32 s50, 1
  s_mov_b32 s51, 0
  s_mov_b32 s53, 8
  v_mov_b32 v8, 0xff800000
  v_mov_b32 v9, 0xff800000
  v_mov_b32 v12, v2
  s_mov_b32 s60, 0
L_maxloop:
  ds_read_b128 v[144:147], v12
  v_add_u32 v12, 1024, v12
  s_waitcnt lgkmcnt(0)
  v_mfma_f32_32x32x16_bf16 v[32:47], v[144:147], v[136:139], 0
  v_mfma_f32_32x32x16_bf16 v[48:63], v[144:147], v[140:143], 0
  s_nop 15
  v_max3_f32 v8, v8, v32, v33
  v_max3_f32 v9, v9, v48, v49
  v_max3_f32 v8, v8, v34, v35
  v_max3_f32 v9, v9, v50, v51
  v_max3_f32 v8, v8, v36, v37
  v_max3_f32 v9, v9, v52, v53
  v_max3_f32 v8, v8, v38, v39
  v_max3_f32 v9, v9, v54, v55
  v_max3_f32 v8, v8, v40, v41
  v_max3_f32 v9, v9, v56, v57
  v_max3_f32 v8, v8, v42, v43
  v_max3_f32 v9, v9, v58, v59
  v_max3_f32 v8, v8, v44, v45
  v_max3_f32 v9, v9, v60, v61
  v_max3_f32 v8, v8, v46, v47
  v_max3_f32 v9, v9, v62, v63
  s_add_u32 s60, s60, 1
  s_cmp_lt_u32 s60, 64
  s_cbranch_scc1 L_maxloop
  s_branch L_setm
L_good:
  s_waitcnt vmcnt(0)
  s_barrier
L_x2b:
  v_mov_b32 v30, 160192
  v_mov_b32 v31, 2
  s_cmp_eq_u32 s26, 6
  s_cbranch_scc0 L_fow_57
  s_lshl_b32 s46, s57, 5
  s_add_u32 s46, s46, s56
  s_lshl_b32 s46, s46, 7
  s_add_u32 s46, s46, 16875520
  v_mov_b32 v28, s27
  v_mov_b32 v29, 0
  s_mov_b64 exec, 1
  buffer_store_dword v28, v29, s[32:35], s46 offen sc1
  s_mov_b64 exec, -1
  s_nop 0
  v_and_b32 v4, 31, v1
  v_lshrrev_b32 v5, 5, v1
  v_lshlrev_b32 v6, 10, v4
  v_lshl_add_u32 v6, v5, 4, v6
  v_lshlrev_b32 v11, 4, v5
  s_lshl_b32 s61, s44, 15
  s_lshl_b32 s46, s52, 6
  s_lshl_b32 s47, s55, 5
  s_add_u32 s46, s46, s47
  s_add_u32 s61, s61, s46
  buffer_load_dwordx4 v[16:19], v6, s[28:31], s61 offen
  s_mov_b32 s72, s18
  s_and_b32 s73, s19, 0xffff
  s_mov_b32 s74, 0x400
  s_mov_b32 s75, 0x20000
  buffer_load_dwordx4 v[20:23], v11, s[72:75], s46 offen
  s_lshr_b32 s46, s44, 3
  s_lshl_b32 s46, s46, 5
  v_and_b32 v4, 31, v1
  v_add_u32 v4, s46, v4
  v_lshlrev_b32 v4, 7, v4
  s_mov_b32 s59, 16875520
  s_mov_b32 s46, 0
L_pfo_60:
  buffer_load_dword v5, v4, s[32:35], s59 offen sc1
  s_waitcnt vmcnt(0)
  v_cmp_ne_u32 vcc, s27, v5
  s_add_u32 s46, s46, 1
  s_cmp_ge_u32 s46, 131072
  s_cbranch_scc1 L_pfo_d_61
  s_nop 1
  s_cbranch_vccnz L_pfo_60
L_pfo_d_61:
  ds_write_b32 v30, v31
  s_branch L_fog_58
L_fow_57:
  v_and_b32 v4, 31, v1
  v_lshrrev_b32 v5, 5, v1
  v_lshlrev_b32 v6, 10, v4
  v_lshl_add_u32 v6, v5, 4, v6
  v_lshlrev_b32 v11, 4, v5
  s_lshl_b32 s61, s44, 15
  s_lshl_b32 s46, s52, 6
  s_lshl_b32 s47, s55, 5
  s_add_u32 s46, s46, s47
  s_add_u32 s61, s61, s46
  buffer_load_dwordx4 v[16:19], v6, s[28:31], s61 offen
  s_mov_b32 s72, s18
  s_and_b32 s73, s19, 0xffff
  s_mov_b32 s74, 0x400
  s_mov_b32 s75, 0x20000
  buffer_load_dwordx4 v[20:23], v11, s[72:75], s46 offen
  s_waitcnt vmcnt(0)
  v_permlane32_swap_b32 v16, v18
  v_permlane32_swap_b32 v17, v19
  v_permlane32_swap_b32 v20, v22
  v_permlane32_swap_b32 v21, v23
  s_nop 1
  v_lshlrev_b32 v24, 16, v16
  v_and_b32 v25, 0xffff0000, v16
  v_lshlrev_b32 v26, 16, v20
  v_and_b32 v27, 0xffff0000, v20
  v_add_f32 v8, v24, v26
  v_add_f32 v9, v25, v27
  v_lshlrev_b32 v24, 16, v17
  v_and_b32 v25, 0xffff0000, v17
  v_lshlrev_b32 v26, 16, v21
  v_and_b32 v27, 0xffff0000, v21
  v_add_f32 v10, v24, v26
  v_add_f32 v11, v25, v27
  v_lshlrev_b32 v24, 16, v18
  v_and_b32 v25, 0xffff0000, v18
  v_lshlrev_b32 v26, 16, v22
  v_and_b32 v27, 0xffff0000, v22
  v_add_f32 v12, v24, v26
  v_add_f32 v13, v25, v27
  v_lshlrev_b32 v24, 16, v19
  v_and_b32 v25, 0xffff0000, v19
  v_lshlrev_b32 v26, 16, v23
  v_and_b32 v27, 0xffff0000, v23
  v_add_f32 v14, v24, v26
  v_add_f32 v15, v25, v27
  s_mov_b32 s72, s20
  s_and_b32 s73, s21, 0xffff
  s_mov_b32 s74, 0x200000
  s_mov_b32 s75, 0x20000
  v_and_b32 v28, 31, v1
  v_lshrrev_b32 v29, 5, v1
  v_lshlrev_b32 v6, 10, v28
  v_lshl_add_u32 v6, v29, 4, v6
  s_cmp_eq_u32 s55, 0
  s_cbranch_scc1 L_x4
  s_mov_b32 s46, 0
L_fos_62:
  ds_read_b32 v26, v30
  s_waitcnt lgkmcnt(0)
  v_readfirstlane_b32 s59, v26
  s_add_u32 s46, s46, 1
  s_cmp_ge_u32 s46, 2097152
  s_cbranch_scc1 L_fog_58
  s_cmp_lg_u32 s59, 2
  s_cbranch_scc1 L_fos_62
L_fog_58:
  s_mul_i32 s46, s44, 118
  s_lshl_b32 s47, s54, 3
  s_add_u32 s46, s46, s47
  s_lshl_b32 s46, s46, 10
  s_add_u32 s46, s46, 8388608
  s_lshl_b32 s47, s54, 13
  s_add_u32 m0, s47, 0
  s_add_u32 s48, s46, 0
  buffer_load_dwordx4 v2, s[32:35], s48 offen offset:0 sc1 lds
  buffer_load_dwordx4 v2, s[32:35], s48 offen offset:1024 sc1 lds
  buffer_load_dwordx4 v2, s[32:35], s48 offen offset:2048 sc1 lds
  buffer_load_dwordx4 v2, s[32:35], s48 offen offset:3072 sc1 lds
  s_add_u32 m0, s47, 4096
  s_add_u32 s48, s46, 4096
  buffer_load_dwordx4 v2, s[32:35], s48 offen offset:0 sc1 lds
  buffer_load_dwordx4 v2, s[32:35], s48 offen offset:1024 sc1 lds
  buffer_load_dwordx4 v2, s[32:35], s48 offen offset:2048 sc1 lds
  buffer_load_dwordx4 v2, s[32:35], s48 offen offset:3072 sc1 lds
  s_cmp_eq_u32 s26, 6
  s_cbranch_scc0 L_x4
  v_permlane32_swap_b32 v16, v18
  v_permlane32_swap_b32 v17, v19
  v_permlane32_swap_b32 v20, v22
  v_permlane32_swap_b32 v21, v23
  s_nop 1
  v_lshlrev_b32 v24, 16, v16
  v_and_b32 v25, 0xffff0000, v16
  v_lshlrev_b32 v26, 16, v20
  v_and_b32 v27, 0xffff0000, v20
  v_add_f32 v8, v24, v26
  v_add_f32 v9, v25, v27
  v_lshlrev_b32 v24, 16, v17
  v_and_b32 v25, 0xffff0000, v17
  v_lshlrev_b32 v26, 16, v21
  v_and_b32 v27, 0xffff0000, v21
  v_add_f32 v10, v24, v26
  v_add_f32 v11, v25, v27
  v_lshlrev_b32 v24, 16, v18
  v_and_b32 v25, 0xffff0000, v18
  v_lshlrev_b32 v26, 16, v22
  v_and_b32 v27, 0xffff0000, v22
  v_add_f32 v12, v24, v26
  v_add_f32 v13, v25, v27
  v_lshlrev_b32 v24, 16, v19
  v_and_b32 v25, 0xffff0000, v19
  v_lshlrev_b32 v26, 16, v23
  v_and_b32 v27, 0xffff0000, v23
  v_add_f32 v14, v24, v26
  v_add_f32 v15, v25, v27
  s_mov_b32 s72, s20
  s_and_b32 s73, s21, 0xffff
  s_mov_b32 s74, 0x200000
  s_mov_b32 s75, 0x20000
  v_and_b32 v28, 31, v1
  v_lshrrev_b32 v29, 5, v1
  v_lshlrev_b32 v6, 10, v28
  v_lshl_add_u32 v6, v29, 4, v6
L_x4:
  s_waitcnt vmcnt(0) lgkmcnt(0)
  s_barrier
  s_lshl_b32 s46, s55, 14
  s_add_u32 s46, s46, 0
  v_add_u32 v4, s46, v2
  ds_read_b128 v[32:35], v4 offset:0
  ds_read_b128 v[36:39], v4 offset:1024
  ds_read_b128 v[40:43], v4 offset:2048
  ds_read_b128 v[44:47], v4 offset:3072
  ds_read_b128 v[48:51], v4 offset:4096
  ds_read_b128 v[52:55], v4 offset:5120
  ds_read_b128 v[56:59], v4 offset:6144
  ds_read_b128 v[60:63], v4 offset:7168
  ds_read_b128 v[64:67], v4 offset:8192
  ds_read_b128 v[68:71], v4 offset:9216
  ds_read_b128 v[72:75], v4 offset:10240
  ds_read_b128 v[76:79], v4 offset:11264
  ds_read_b128 v[80:83], v4 offset:12288
  ds_read_b128 v[84:87], v4 offset:13312
  ds_read_b128 v[88:91], v4 offset:14336
  ds_read_b128 v[92:95], v4 offset:15360
  s_waitcnt lgkmcnt(15)
  v_mfma_f32_32x32x16_bf16 v[168:183], v[216:219], v[32:35], v[168:183]
  s_waitcnt lgkmcnt(14)
  v_mfma_f32_32x32x16_bf16 v[168:183], v[220:223], v[36:39], v[168:183]
  s_waitcnt lgkmcnt(13)
  v_mfma_f32_32x32x16_bf16 v[168:183], v[224:227], v[40:43], v[168:183]
  s_waitcnt lgkmcnt(12)
  v_mfma_f32_32x32x16_bf16 v[168:183], v[228:231], v[44:47], v[168:183]
  s_waitcnt lgkmcnt(11)
  v_mfma_f32_32x32x16_bf16 v[168:183], v[232:235], v[48:51], v[168:183]
  s_waitcnt lgkmcnt(10)
  v_mfma_f32_32x32x16_bf16 v[168:183], v[236:239], v[52:55], v[168:183]
  s_waitcnt lgkmcnt(9)
  v_mfma_f32_32x32x16_bf16 v[168:183], v[240:243], v[56:59], v[168:183]
  s_waitcnt lgkmcnt(8)
  v_mfma_f32_32x32x16_bf16 v[168:183], v[244:247], v[60:63], v[168:183]
  s_waitcnt lgkmcnt(7)
  v_mfma_f32_32x32x16_bf16 v[168:183], v[184:187], v[64:67], v[168:183]
  s_waitcnt lgkmcnt(6)
  v_mfma_f32_32x32x16_bf16 v[168:183], v[188:191], v[68:71], v[168:183]
  s_waitcnt lgkmcnt(5)
  v_mfma_f32_32x32x16_bf16 v[168:183], v[192:195], v[72:75], v[168:183]
  s_waitcnt lgkmcnt(4)
  v_mfma_f32_32x32x16_bf16 v[168:183], v[196:199], v[76:79], v[168:183]
  s_waitcnt lgkmcnt(3)
  v_mfma_f32_32x32x16_bf16 v[168:183], v[200:203], v[80:83], v[168:183]
  s_waitcnt lgkmcnt(2)
  v_mfma_f32_32x32x16_bf16 v[168:183], v[204:207], v[84:87], v[168:183]
  s_waitcnt lgkmcnt(1)
  v_mfma_f32_32x32x16_bf16 v[168:183], v[208:211], v[88:91], v[168:183]
  s_waitcnt lgkmcnt(0)
  v_mfma_f32_32x32x16_bf16 v[168:183], v[212:215], v[92:95], v[168:183]
  s_lshl_b32 s46, s26, 11
  s_add_u32 s46, s46, 32768
  v_add_u32 v4, s46, v2
  s_xor_b32 s47, s26, 4
  s_lshl_b32 s47, s47, 11
  s_add_u32 s47, s47, 32768
  v_add_u32 v5, s47, v2
  s_nop 12
  s_cmp_eq_u32 s55, 0
  s_cbranch_scc0 L_fk1_63
  ds_write_b128 v4, v[176:179]
  ds_write_b128 v4, v[180:183] offset:1024
  v_mov_b32 v32, v168
  v_mov_b32 v33, v169
  v_mov_b32 v34, v170
  v_mov_b32 v35, v171
  v_mov_b32 v36, v172
  v_mov_b32 v37, v173
  v_mov_b32 v38, v174
  v_mov_b32 v39, v175
  s_branch L_fk2_64
L_fk1_63:
  ds_write_b128 v4, v[168:171]
  ds_write_b128 v4, v[172:175] offset:1024
  v_mov_b32 v32, v176
  v_mov_b32 v33, v177
  v_mov_b32 v34, v178
  v_mov_b32 v35, v179
  v_mov_b32 v36, v180
  v_mov_b32 v37, v181
  v_mov_b32 v38, v182
  v_mov_b32 v39, v183
L_fk2_64:
  s_waitcnt lgkmcnt(0)
  s_barrier
  ds_read_b128 v[40:43], v5
  ds_read_b128 v[44:47], v5 offset:1024
  v_add_f32 v32, v32, v8
  v_add_f32 v33, v33, v9
  v_add_f32 v34, v34, v10
  v_add_f32 v35, v35, v11
  v_add_f32 v36, v36, v12
  v_add_f32 v37, v37, v13
  v_add_f32 v38, v38, v14
  v_add_f32 v39, v39, v15
  s_waitcnt lgkmcnt(0)
  v_add_f32 v32, v32, v40
  v_add_f32 v33, v33, v41
  v_add_f32 v34, v34, v42
  v_add_f32 v35, v35, v43
  v_add_f32 v36, v36, v44
  v_add_f32 v37, v37, v45
  v_add_f32 v38, v38, v46
  v_add_f32 v39, v39, v47
  v_cvt_pk_bf16_f32 v48, v32, v33
  v_cvt_pk_bf16_f32 v49, v34, v35
  v_cvt_pk_bf16_f32 v50, v36, v37
  v_cvt_pk_bf16_f32 v51, v38, v39
  s_nop 1
  v_permlane32_swap_b32 v48, v50
  v_permlane32_swap_b32 v49, v51
  s_nop 0
  buffer_store_dwordx4 v[48:51], v6, s[72:75], s61 offen
L_fin:
L_end:
  s_endpgm
.section .rodata,"a"
.p2align 6
.amdhsa_kernel parallel_sum__softmax_full_mha__mixer_channel_mlp__prompt_kernel
  .amdhsa_next_free_vgpr 256
  .amdhsa_next_free_sgpr 96
  .amdhsa_accum_offset 256
  .amdhsa_group_segment_fixed_size 0
  .amdhsa_kernarg_size 88
  .amdhsa_user_sgpr_count 2
  .amdhsa_user_sgpr_kernarg_segment_ptr 1
  .amdhsa_system_sgpr_workgroup_id_x 1
  .amdhsa_float_denorm_mode_32 3
.end_amdhsa_kernel
```
